```python
import torch

def _softmax(x, axis=-1):
    return torch.softmax(x, dim=axis)
def _gelu(x):
    return torch.nn.functional.gelu(x, approximate="tanh")
def _silu(x):
    return torch.nn.functional.silu(x)
def _sigmoid(x):
    return torch.sigmoid(x)
def _layernorm(x, axis=-1, eps=1e-5):
    m = x.mean(dim=axis, keepdim=True)
    v = x.var(dim=axis, keepdim=True, unbiased=False)
    return (x - m) / torch.sqrt(v + eps)
def _scatter_add(tgt, idx, src, axis=0):
    return tgt.clone().index_add_(axis, idx, src)
def _segment_sum(src, seg, n):
    out = torch.zeros((n,) + src.shape[1:], dtype=src.dtype)
    return out.index_add_(0, seg, src)
def _pad(x, pw):
    flat = tuple(v for pair in reversed(pw) for v in pair)
    return torch.nn.functional.pad(x, flat)

kernel_name = 'interleave_layers__ssm_conv_s4__sliding_local_dilated__prompt'

def setup_inputs():

    _w = (lambda a: (lambda t: t.to(torch.bfloat16) if t.is_floating_point() else t)(torch.as_tensor(a)))
    def _A_setup():
        B, L, D, N = 1, 2048, 512, 128
        A_re = -(lambda _x: torch.exp(torch.as_tensor(_x)))((lambda *s: torch.randn(*s, dtype=torch.bfloat16) * 1.6)(D, N))
        A_im = torch.pi * (lambda *s: torch.randn(*s, dtype=torch.bfloat16) * 0.1)(D, N)
        B_re = (lambda *s: torch.randn(*s, dtype=torch.bfloat16) * 0.1)(D, N)
        B_im = (lambda *s: torch.randn(*s, dtype=torch.bfloat16) * 0.1)(D, N)
        C_re = (lambda *s: torch.randn(*s, dtype=torch.bfloat16) * 0.1)(D, N)
        C_im = (lambda *s: torch.randn(*s, dtype=torch.bfloat16) * 0.1)(D, N)
        log_dt = (lambda *s: torch.randn(*s, dtype=torch.bfloat16) * 0.1)(D) * 0.5 - 4.0
        Dskip = (lambda *s: torch.randn(*s, dtype=torch.bfloat16) * 0.1)(D)
        return {
            "u": _w((lambda *s: torch.randn(*s, dtype=torch.bfloat16) * 0.05)(B, L, D)),
            "A_re": _w(A_re),
            "A_im": _w(A_im),
            "B_re": _w(B_re),
            "B_im": _w(B_im),
            "C_re": _w(C_re),
            "C_im": _w(C_im),
            "log_dt": _w(log_dt),
            "Dskip": _w(Dskip),
        }
    _A_in = _A_setup()

    def _B_setup():
        B, S, D = 1, 2048, 512
        return {
            "x": _w((lambda *s: torch.randn(*s, dtype=torch.bfloat16) * 0.05)(B, S, D)),
            "wqkv": _w((lambda *s: torch.randn(*s, dtype=torch.bfloat16) * 0.05)(D, 3 * D)),
            "wo": _w((lambda *s: torch.randn(*s, dtype=torch.bfloat16) * 0.05)(D, D)),
        }
    _B_in = _B_setup()

    return {
        "A_u": _A_in["u"],
        "A_A_re": _A_in["A_re"],
        "A_A_im": _A_in["A_im"],
        "A_B_re": _A_in["B_re"],
        "A_B_im": _A_in["B_im"],
        "A_C_re": _A_in["C_re"],
        "A_C_im": _A_in["C_im"],
        "A_log_dt": _A_in["log_dt"],
        "A_Dskip": _A_in["Dskip"],
        "B_x": _B_in["x"],
        "B_wqkv": _B_in["wqkv"],
        "B_wo": _B_in["wo"],
    }

def reference(A_u, A_A_re, A_A_im, A_B_re, A_B_im, A_C_re, A_C_im, A_log_dt, A_Dskip, B_x, B_wqkv, B_wo):
    def _A_ref(u, A_re, A_im, B_re, B_im, C_re, C_im, log_dt, Dskip):
        Bsz, L, D = u.shape
        dt = torch.exp(log_dt)[:, None]
        A = A_re + 1j * A_im
        Bc = B_re + 1j * B_im
        Cc = C_re + 1j * C_im
        logdA = dt * A
        dB = dt * Bc
        l = (lambda x, dt: x.to(dt))(torch.arange(L), A_re.dtype)
        P = torch.exp(logdA[:, :, None] * l[None, None, :])
        K = torch.einsum("dn,dnl,dn->dl", Cc, P, dB).real
        L2 = 2 * L
        Kp = _pad(K, ((0, 0), (0, L)))
        up = (lambda x, *d: x.permute(*d))(u, 0, 2, 1)
        up = _pad(up, ((0, 0), (0, 0), (0, L)))
        Kf = (lambda x, axes=(-2,-1): torch.fft.rfft2(x.float(), dim=axes))(Kp[:, None, :], axes=(-2, -1))
        Uf = (lambda x, axes=(-2,-1): torch.fft.rfft2(x.float(), dim=axes))(up[:, :, None, :], axes=(-2, -1))
        Yf = Uf * Kf[None, :, :, :]
        y = (lambda x, s, axes=(-2,-1): torch.fft.irfft2(x, s=s, dim=axes).to(torch.bfloat16))(Yf, (1, L2), axes=(-2, -1))[:, :, 0, :L]
        y = (lambda x, *d: x.permute(*d))(y, 0, 2, 1) + u * Dskip[None, None, :]
        return y

    def _B_ref(x, wqkv, wo):
        B, S, D = x.shape
        H = 32; Dh = D // H
        W, dil = 8, 2
        qkv = (lambda x, *d: x.permute(*d))((x @ wqkv).reshape(B, S, 3, H, Dh), 2, 0, 3, 1, 4)
        q, k, v = qkv[0], qkv[1], qkv[2]
        scale = Dh ** -0.5
        pos = torch.arange(S)
        off = torch.arange(W) * dil
        idx = pos[:, None] - off[None, :]
        mask = idx >= 0
        idx_c = torch.where(mask, idx, 0).reshape(-1)
        kg = k[:, :, idx_c, :].reshape(B, H, S, W, Dh)
        vg = v[:, :, idx_c, :].reshape(B, H, S, W, Dh)
        logits = torch.einsum("bhsd,bhswd->bhsw", q, kg) * scale
        logits = torch.where(mask[None, None, :, :], logits, -1e9)
        attn = _softmax(logits, axis=-1)
        o = torch.einsum("bhsw,bhswd->bhsd", attn, vg)
        return (lambda x, *d: x.permute(*d))(o, 0, 2, 1, 3).reshape(B, S, D) @ wo

    x = A_u
    x = x + _A_ref(_layernorm(x, axis=-1), A_A_re, A_A_im, A_B_re, A_B_im, A_C_re, A_C_im, A_log_dt, A_Dskip)
    x = x + _B_ref(_layernorm(x, axis=-1), B_wqkv, B_wo)
    x = x + _A_ref(_layernorm(x, axis=-1), A_A_re, A_A_im, A_B_re, A_B_im, A_C_re, A_C_im, A_log_dt, A_Dskip)
    x = x + _B_ref(_layernorm(x, axis=-1), B_wqkv, B_wo)
    return x
```

```asm
; @launch grid=(256,1,1) block=(256,1,1) lds=156608
.amdgcn_target "amdgcn-amd-amdhsa--gfx950"
.text
.globl interleave_layers__ssm_conv_s4__sliding_local_dilated__prompt_kernel
.p2align 12
.p2align 8
.type interleave_layers__ssm_conv_s4__sliding_local_dilated__prompt_kernel,@function
interleave_layers__ssm_conv_s4__sliding_local_dilated__prompt_kernel:
    s_cmp_ge_u32 s2, 256
    s_cbranch_scc1 the_end
    s_load_dwordx16 s[80:95], s[0:1], 0
    s_load_dwordx2 s[96:97], s[0:1], 64
    s_load_dwordx4 s[68:71], s[0:1], 80
    s_load_dwordx2 s[8:9], s[0:1], 96
    s_load_dwordx2 s[4:5], s[0:1], 112
    s_getpc_b64 s[98:99]
code_pf:
    v_lshrrev_b32 v2, 6, v0
    v_and_b32 v1, 63, v0
    v_readfirstlane_b32 s12, v2
    v_lshlrev_b32 v68, 5, v0
    global_load_dword v69, v68, s[98:99]
    s_and_b32 s3, s2, 7
    s_lshr_b32 s17, s2, 3
    s_lshl_b32 s15, s3, 5
    s_add_u32 s15, s15, s17
    s_and_b32 s18, s17, 3
    s_lshl_b32 s13, s3, 2
    s_add_u32 s13, s13, s18
    s_lshr_b32 s14, s17, 2
    s_lshl_b32 s31, s14, 2
    s_add_u32 s31, s31, s12
    s_mov_b32 s6, 18874368
    s_mov_b32 s7, 0x20000
    s_mov_b32 s10, 0x200000
    s_mov_b32 s11, 0x20000
    v_mov_b32 v72, 0
    v_mov_b32 v73, 0
    v_mov_b32 v74, 0
    v_mov_b32 v75, 0
    v_mov_b32 v76, 0
    v_mov_b32 v77, 0
    v_mov_b32 v78, 0
    v_mov_b32 v79, 0
    s_lshl_b32 s18, s13, 5
    s_lshr_b32 s19, s14, 2
    s_lshl_b32 s62, s19, 14
    s_lshl_b32 s19, s19, 10
    s_add_u32 s19, s19, s18
    s_and_b32 s63, s14, 3
    s_add_u32 s19, s19, s63
    s_lshl_b32 s63, s63, 10
    s_add_u32 s62, s62, s63
    s_lshr_b32 s63, s12, 1
    s_lshl_b32 s63, s63, 4
    s_add_u32 s19, s19, s63
    s_and_b32 s63, s12, 1
    s_lshl_b32 s63, s63, 2
    s_add_u32 s19, s19, s63
    s_lshl_b32 s19, s19, 10
    v_lshl_add_u32 v104, v1, 4, s19
    v_add_u32 v105, 0x2000, v104
    v_lshrrev_b32 v118, 3, v0
    v_and_b32 v119, 7, v0
    v_lshlrev_b32 v119, 4, v119
    s_lshl_b32 s18, s18, 10
    s_lshl_b32 s19, s14, 7
    s_add_u32 s18, s18, s19
    v_lshl_add_u32 v106, v118, 10, v119
    v_add_u32 v106, s18, v106
    v_add_u32 v107, 0x100000, v106
    s_waitcnt lgkmcnt(0)
    global_load_dwordx4 v[80:83], v104, s[80:81]
    global_load_dwordx4 v[84:87], v105, s[80:81]
    global_load_dwordx4 v[88:91], v106, s[80:81]
    global_load_dwordx4 v[92:95], v107, s[80:81]
    s_cmp_lt_u32 s17, 24
    s_mov_b32 s24, 1024
    s_cmov_b32 s24, 3072
    s_cselect_b32 s25, 0, 24
    s_cselect_b32 s60, s68, s70
    s_cselect_b32 s61, s69, s71
    s_sub_u32 s25, s17, s25
    s_lshl_b32 s63, s3, 6
    s_mul_i32 s63, s63, s24
    s_lshl_b32 s19, s25, 7
    s_add_u32 s63, s63, s19
    v_mul_u32_u24 v108, s24, v118
    v_add3_u32 v108, v108, v119, s63
    s_lshl_b32 s19, s24, 5
    v_add_u32 v109, s19, v108
    global_load_dwordx4 v[96:99], v108, s[60:61]
    global_load_dwordx4 v[100:103], v109, s[60:61]
    v_and_b32 v2, 15, v1
    v_lshrrev_b32 v3, 4, v1
    v_lshlrev_b32 v4, 4, v1
    v_mul_u32_u24 v110, 160, v118
    v_add_u32 v110, v110, v119
    v_add_u32 v110, 132032, v110
    v_and_b32 v117, 3, v1
    v_bfe_u32 v112, v1, 2, 2
    v_lshlrev_b32 v117, 3, v117
    v_lshl_add_u32 v113, s12, 5, v117
    v_add_u32 v113, 132032, v113
    v_lshl_add_u32 v114, v3, 3, v112
    v_mul_u32_u24 v114, 160, v114
    v_add_u32 v114, v114, v113
    s_cmp_lt_u32 s17, 24
    s_cselect_b32 s18, 2, 3
    s_mov_b32 s19, 640
    s_cmov_b32 s19, 2560
    v_lshlrev_b32 v115, s18, v3
    v_add_u32 v115, v115, v112
    v_mul_u32_u24 v115, 160, v115
    v_add_u32 v115, v115, v113
    v_add_u32 v116, s19, v115
    s_and_b32 s42, s17, 7
    s_lshl_b32 s42, s42, 2
    s_add_u32 s42, s42, s12
    s_lshl_b32 s42, s42, 12
    s_lshl_b32 s19, s3, 18
    s_add_u32 s42, s42, s19
    s_lshr_b32 s19, s17, 3
    s_lshl_b32 s19, s19, 10
    s_add_u32 s42, s42, s19
    s_add_u32 s42, s42, 12582912
    s_add_u32 s43, s42, 131072
    s_lshl_b32 s41, s13, 15
    s_lshl_b32 s19, s31, 8
    s_add_u32 s41, s41, s19
    s_add_u32 s44, s41, 1048576
    v_lshlrev_b32 v117, 13, v3
    v_lshl_add_u32 v117, v2, 4, v117
    s_lshr_b32 s19, s13, 3
    s_lshl_b32 s33, s19, 12
    s_and_b32 s19, s13, 7
    s_lshl_b32 s19, s19, 7
    s_add_u32 s33, s33, s19
    s_add_u32 s40, s62, s33
    s_add_u32 s40, s40, 14680064
    s_lshr_b32 s18, s12, 1
    s_and_b32 s19, s12, 1
    s_lshl_b32 s19, s19, 8
    s_mul_i32 s23, s18, 4672
    s_add_u32 s23, s23, s19
    s_add_u32 s23, s23, 123168
    v_lshl_add_u32 v7, v3, 4, s23
    v_lshlrev_b32 v126, 5, v2
    v_sub_u32 v7, v7, v126
    s_mul_i32 s23, s18, 8320
    s_add_u32 s23, s23, s19
    s_add_u32 s23, s23, 106048
    v_add_u32 v126, 1, v2
    v_and_b32 v127, 1, v126
    v_mul_u32_u24 v127, 4160, v127
    v_and_b32 v126, 30, v126
    v_lshl_add_u32 v8, v126, 1, s23
    v_lshl_add_u32 v8, v3, 4, v8
    v_add_u32 v8, v8, v127
    v_add_u32 v9, 1024, v8
    v_add_u32 v10, 2048, v8
    v_add_u32 v11, 3072, v8
    v_bfe_u32 v126, v2, 1, 2
    v_xor_b32 v126, v126, v3
    v_xor_b32 v126, s18, v126
    v_lshlrev_b32 v126, 4, v126
    v_lshl_add_u32 v12, v2, 6, v126
    s_lshl_b32 s23, s12, 12
    s_add_u32 s23, s23, 140224
    v_add_u32 v12, s23, v12
    v_lshrrev_b32 v126, 2, v1
    v_and_b32 v127, 1, v1
    v_lshl_add_u32 v125, v126, 1, v127
    v_lshlrev_b32 v5, 14, v126
    v_lshlrev_b32 v13, 6, v126
    v_and_b32 v126, 3, v1
    v_lshl_add_u32 v5, v126, 4, v5
    s_lshl_b32 s23, s12, 18
    v_add_u32 v5, s23, v5
    v_bfe_u32 v126, v1, 3, 2
    v_lshlrev_b32 v127, 1, v127
    v_xor_b32 v126, v126, v127
    v_bfe_u32 v127, v1, 1, 1
    v_xor_b32 v126, v126, v127
    v_lshl_add_u32 v13, v126, 4, v13
    v_lshl_add_u32 v13, v127, 13, v13
    s_lshl_b32 s23, s12, 10
    s_add_u32 s19, s23, 140224
    v_add_u32 v13, s19, v13
    v_xor_b32 v14, 16, v13
    s_lshl_b32 s23, s23, 2
    v_lshl_add_u32 v6, v125, 7, s23
    v_lshrrev_b32 v126, 3, v6
    v_lshlrev_b32 v248, 6, v6
    v_lshl_add_u32 v248, v127, 4, v248
    v_add_u32 v6, s23, v4
    v_mul_u32_u24 v15, 4672, v127
    v_sub_u32 v15, v15, v126
    v_add_u32 v15, 124720, v15
    v_lshlrev_b32 v40, 3, v1
    v_add_u32 v41, 65536, v40
    s_lshl_b32 s18, s12, 12
    v_add_u32 v42, s18, v40
    v_add_u32 v43, s18, v41
    v_mov_b32 v16, 0x3f803f80
    v_mov_b32 v17, 0x3f803f80
    v_mov_b32 v18, 0x3f803f80
    v_mov_b32 v19, 0x3f803f80
    v_lshrrev_b32 v126, 2, v2
    v_cmp_eq_u32 vcc, v126, v3
    s_mov_b32 s19, 98304
    v_lshl_add_u32 v53, v1, 3, s19
    s_lshl_b32 s18, s12, 9
    s_add_u32 s18, s18, s19
    v_lshl_add_u32 v126, v2, 3, s18
    v_add_u32 v127, 2048, v53
    v_cndmask_b32 v52, v127, v126, vcc
    s_mov_b64 s[70:71], vcc
    v_mov_b32 v127, 1073741824
    s_lshl_b32 s18, s12, 6
    s_cmp_lt_u32 s12, 2
    s_cselect_b32 s18, s18, 1073741824
    v_lshl_add_u32 v64, v2, 2, s18
    v_lshl_add_u32 v64, v3, 10, v64
    v_bfe_u32 v126, v1, 2, 1
    v_bfe_u32 v125, v1, 3, 1
    v_lshl_add_u32 v126, v126, 1, v125
    v_lshl_add_u32 v67, v126, 2, v3
    v_and_b32 v125, 1, v1
    v_xor_b32 v125, 1, v125
    v_xor_b32 v126, v126, v125
    v_lshl_add_u32 v67, v126, 4, v67
    v_lshlrev_b32 v67, 2, v67
    s_mul_i32 s18, s12, 1152
    s_add_u32 s18, s18, 101376
    v_add_u32 v54, s18, v4
    v_lshl_add_u32 v56, v2, 4, s18
    v_lshl_add_u32 v57, v3, 6, s18
    s_add_u32 s18, s18, 1024
    v_lshl_add_u32 v55, v1, 1, s18
    v_lshl_add_u32 v60, v3, 3, s18
    v_lshlrev_b32 v61, 4, v1
    v_lshlrev_b32 v126, 12, v1
    v_cmp_gt_u32 vcc, 8, v1
    s_nop 1
    v_cndmask_b32 v62, v127, v126, vcc
    v_cmp_eq_u32 vcc, 0, v1
    s_nop 1
    v_cndmask_b32 v63, v127, v1, vcc
    v_and_b32 v126, 1, v3
    v_lshlrev_b32 v44, 14, v126
    v_lshrrev_b32 v126, 1, v3
    v_lshl_add_u32 v44, v126, 8, v44
    v_lshl_add_u32 v44, v2, 4, v44
    v_lshlrev_b32 v126, 5, v2
    v_lshl_add_u32 v126, v3, 3, v126
    s_lshl_b32 s18, s31, 9
    v_add_u32 v45, s18, v126
    v_add_u32 v46, s18, v40
    s_lshl_b32 s19, s12, 9
    s_add_u32 s19, s19, 132032
    v_add_u32 v47, s19, v126
    v_and_b32 v126, 31, v1
    v_lshlrev_b32 v126, 4, v126
    v_lshrrev_b32 v127, 5, v1
    v_lshl_add_u32 v48, v127, 11, v126
    v_add_u32 v48, s19, v48
    v_lshl_add_u32 v50, v127, 14, v126
    s_lshl_b32 s19, s13, 15
    s_add_u32 s18, s18, s19
    v_add_u32 v50, s18, v50
    s_and_b32 s18, s12, 1
    s_lshl_b32 s18, s18, 11
    s_add_u32 s18, s18, 132032
    v_add_u32 v49, s18, v40
    s_lshl_b32 s66, s12, 12
    s_lshl_b32 s18, s13, 15
    s_add_u32 s64, s18, s66
    s_add_u32 s64, s64, 2097152
    s_cmp_eq_u32 s13, 0
    s_cselect_b32 s65, 0, 16384
    s_add_u32 s18, s18, 8388608
    s_lshl_b32 s19, s31, 9
    s_add_u32 s73, s18, s19
    s_lshl_b32 s19, s12, 12
    s_add_u32 s74, s18, s19
    s_lshr_b32 s18, s15, 5
    s_lshl_b32 s18, s18, 12
    s_lshl_b32 s19, s12, 10
    s_add_u32 s18, s18, s19
    s_add_u32 s67, s18, 14815232
    s_lshl_b32 s18, s15, 4
    s_add_u32 s72, s18, 14815232
    s_lshl_b32 s75, s15, 6
    s_lshl_b32 s34, s31, 12
    s_add_u32 s34, s34, 12582912
    s_mul_i32 s18, s12, 18432
    v_mul_u32_u24 v120, 144, v1
    v_add_u32 v120, s18, v120
    v_lshrrev_b32 v121, 5, v1
    v_lshlrev_b32 v121, 1, v121
    v_lshrrev_b32 v126, 1, v112
    v_lshl_add_u32 v121, v126, 3, v121
    v_mul_u32_u24 v121, 144, v121
    v_and_b32 v126, 1, v112
    v_lshl_add_u32 v121, v126, 6, v121
    v_and_b32 v126, 1, v3
    v_lshl_add_u32 v121, v126, 5, v121
    v_and_b32 v126, 3, v1
    v_lshl_add_u32 v121, v126, 3, v121
    v_add_u32 v121, s18, v121
    v_add_u32 v122, s18, v4
    s_xor_b32 s19, s12, 1
    s_mul_i32 s19, s19, 18432
    v_add_u32 v123, s19, v4
    s_mul_i32 s19, s12, 4160
    s_add_u32 s19, s19, 106048
    v_add_u32 v124, s19, v4
    s_mov_b32 s28, 0x3b000000
    s_mov_b32 s29, 0x3727c5ac
    s_mov_b32 s30, 0x3eb8aa3b
    s_mov_b32 s16, 0
    s_cmp_eq_u32 s13, 0
    s_cselect_b32 s19, 0xf149f2ca, 0
    v_mov_b32 v36, s19
    v_mov_b32 v37, s19
    v_mov_b32 v38, s19
    v_mov_b32 v39, s19
    v_and_b32 v126, 3, v1
    v_cmp_eq_u32 s[48:49], 1, v126
    v_cmp_eq_u32 s[50:51], 2, v126
    v_cmp_eq_u32 s[52:53], 3, v126
    v_and_b32 v126, 1, v2
    v_lshl_add_u32 v127, v3, 2, v126
    v_cmp_eq_u32 s[54:55], 1, v126
    v_cmp_le_u32 s[56:57], v127, v2
    v_lshl_add_u32 v58, v126, 4, v57
    v_add_u32 v127, 2, v127
    v_cmp_le_u32 s[58:59], v127, v2
    v_add_u32 v59, 32, v58
    v_add_u32 v126, 256, v58
    v_add_u32 v127, 256, v59
    v_cndmask_b32 v58, v58, v126, s[56:57]
    v_cndmask_b32 v59, v59, v127, s[58:59]
    v_mov_b32 v126, 0xffff
    v_mov_b32 v127, 0xffff0000
    v_cndmask_b32 v126, v126, v127, s[54:55]
    v_cndmask_b32 v32, v126, 0, s[56:57]
    v_cndmask_b32 v33, v126, 0, s[58:59]
    v_cndmask_b32 v34, 0, v126, s[56:57]
    v_cndmask_b32 v35, 0, v126, s[58:59]
    v_mov_b32 v252, 0
    v_mov_b32 v253, 0
    v_mov_b32 v254, 0
    v_mov_b32 v255, 0
    v_lshrrev_b32 v126, 5, v1
    v_mul_u32_u24 v126, 4160, v126
    v_add_u32 v126, v126, v4
    v_add_u32 v126, 126784, v126
    ds_write_b128 v126, v[252:255]
    s_mov_b64 exec, 3
    ds_write_b128 v124, v[252:255]
    s_mov_b64 exec, -1
    v_accvgpr_write_b32 a252, -1
    v_accvgpr_write_b32 a253, -1
    v_accvgpr_write_b32 a254, -1
    v_accvgpr_write_b32 a255, -1
    s_lshl_b32 s18, s15, 9
    v_lshl_add_u32 v70, v0, 1, s18
    s_lshr_b32 s19, s12, 1
    s_lshl_b32 s18, s15, 1
    s_add_u32 s19, s18, s19
    s_lshl_b32 s19, s19, 1
    v_mov_b32 v71, s19
    global_load_short_d16_hi v78, v71, s[94:95]
    global_load_short_d16_hi v72, v70, s[82:83]
    global_load_short_d16_hi v73, v70, s[84:85]
    global_load_short_d16_hi v74, v70, s[86:87]
    global_load_short_d16_hi v75, v70, s[88:89]
    global_load_short_d16_hi v76, v70, s[90:91]
    global_load_short_d16_hi v77, v70, s[92:93]
    v_bfe_u32 v105, v1, 1, 1
    v_add_u32 v105, s18, v105
    v_lshlrev_b32 v105, 1, v105
    global_load_short_d16_hi v79, v105, s[96:97]
    v_mov_b32 v111, 0
    s_mov_b32 s19, 14811136
    buffer_load_dword v65, v111, s[4:7], s19 offen sc1
    s_and_b32 s18, s17, 3
    s_lshl_b32 s18, s18, 14
    v_lshlrev_b32 v68, 6, v0
    v_add_u32 v68, s18, v68
    v_min_u32 v68, code_end-code_pf-4, v68
    global_load_dword v249, v68, s[98:99]
    v_lshlrev_b32 v105, 2, v1
    s_lshl_b32 s18, s2, 7
    s_add_u32 s18, s18, 14712832
    s_cmp_eq_u32 s12, 0
    s_cselect_b32 s19, 0, 1073741824
    v_add_u32 v105, s19, v105
    s_mov_b32 exec_hi, 0
    buffer_store_dword v111, v105, s[4:7], s18 offen sc1
    s_mov_b64 exec, -1
    s_lshl_b32 s18, s2, 12
    s_lshl_b32 s19, s12, 10
    s_add_u32 s18, s18, s19
    s_add_u32 s18, s18, 2097152
    buffer_store_dwordx4 a[252:255], v4, s[4:7], s18 offen sc1
    s_mov_b32 s26, 100000
    s_mov_b32 s27, 100000
    s_mov_b32 s35, 1
    s_lshl_b32 s46, s3, 13
    s_lshl_b32 s19, s17, 8
    s_add_u32 s46, s46, s19
    s_lshl_b32 s19, s12, 6
    s_add_u32 s46, s46, s19
    s_add_u32 s46, s46, 14745600
    v_lshlrev_b32 v125, 2, v1
    v_mov_b32 v126, 105984
    ds_write_b32 v126, v111
    s_mov_b32 s18, 0x3f803f80
    v_mov_b32 v130, 0x41000000
    v_mov_b32 v131, 0
    v_mov_b32 v134, 0x41000000
    v_mov_b32 v135, 0
    s_waitcnt vmcnt(17)
    v_dot2_f32_bf16 v128, v80, s18, 0
    v_dot2_f32_bf16 v129, v80, v80, 0
    s_waitcnt vmcnt(16)
    v_dot2_f32_bf16 v132, v84, s18, 0
    v_dot2_f32_bf16 v133, v84, v84, 0
    v_dot2_f32_bf16 v128, v81, s18, v128
    v_dot2_f32_bf16 v129, v81, v81, v129
    v_dot2_f32_bf16 v132, v85, s18, v132
    v_dot2_f32_bf16 v133, v85, v85, v133
    v_dot2_f32_bf16 v128, v82, s18, v128
    v_dot2_f32_bf16 v129, v82, v82, v129
    v_dot2_f32_bf16 v132, v86, s18, v132
    v_dot2_f32_bf16 v133, v86, v86, v133
    v_dot2_f32_bf16 v128, v83, s18, v128
    v_dot2_f32_bf16 v129, v83, v83, v129
    v_dot2_f32_bf16 v132, v87, s18, v132
    v_dot2_f32_bf16 v133, v87, v87, v133
    v_add_f32_dpp v128, v128, v128 row_shr:1 row_mask:0xf bank_mask:0xf bound_ctrl:1
    s_nop 0
    v_add_f32_dpp v132, v132, v132 row_shr:1 row_mask:0xf bank_mask:0xf bound_ctrl:1
    v_add_f32_dpp v129, v129, v129 row_shr:1 row_mask:0xf bank_mask:0xf bound_ctrl:1
    v_add_f32_dpp v133, v133, v133 row_shr:1 row_mask:0xf bank_mask:0xf bound_ctrl:1
    v_add_f32_dpp v128, v128, v128 row_shr:2 row_mask:0xf bank_mask:0xf bound_ctrl:1
    v_add_f32_dpp v132, v132, v132 row_shr:2 row_mask:0xf bank_mask:0xf bound_ctrl:1
    v_add_f32_dpp v129, v129, v129 row_shr:2 row_mask:0xf bank_mask:0xf bound_ctrl:1
    v_add_f32_dpp v133, v133, v133 row_shr:2 row_mask:0xf bank_mask:0xf bound_ctrl:1
    v_add_f32_dpp v128, v128, v128 row_shr:4 row_mask:0xf bank_mask:0xf bound_ctrl:1
    v_add_f32_dpp v132, v132, v132 row_shr:4 row_mask:0xf bank_mask:0xf bound_ctrl:1
    v_add_f32_dpp v129, v129, v129 row_shr:4 row_mask:0xf bank_mask:0xf bound_ctrl:1
    v_add_f32_dpp v133, v133, v133 row_shr:4 row_mask:0xf bank_mask:0xf bound_ctrl:1
    v_add_f32_dpp v128, v128, v128 row_shr:8 row_mask:0xf bank_mask:0xf bound_ctrl:1
    v_add_f32_dpp v132, v132, v132 row_shr:8 row_mask:0xf bank_mask:0xf bound_ctrl:1
    v_add_f32_dpp v129, v129, v129 row_shr:8 row_mask:0xf bank_mask:0xf bound_ctrl:1
    v_add_f32_dpp v133, v133, v133 row_shr:8 row_mask:0xf bank_mask:0xf bound_ctrl:1
    v_add_f32_dpp v128, v128, v128 row_bcast:15 row_mask:0xa bank_mask:0xf
    v_add_f32_dpp v132, v132, v132 row_bcast:15 row_mask:0xa bank_mask:0xf
    v_add_f32_dpp v129, v129, v129 row_bcast:15 row_mask:0xa bank_mask:0xf
    v_add_f32_dpp v133, v133, v133 row_bcast:15 row_mask:0xa bank_mask:0xf
    v_add_f32_dpp v128, v128, v128 row_bcast:31 row_mask:0xc bank_mask:0xf
    v_add_f32_dpp v132, v132, v132 row_bcast:31 row_mask:0xc bank_mask:0xf
    v_add_f32_dpp v129, v129, v129 row_bcast:31 row_mask:0xc bank_mask:0xf
    v_add_f32_dpp v133, v133, v133 row_bcast:31 row_mask:0xc bank_mask:0xf
    s_lshl_b32 s18, s12, 5
    s_add_u32 s18, s18, 98304
    v_mov_b32 v108, s18
    v_add_u32 v109, 98304, v125
    s_mov_b32 exec_lo, 0
    s_mov_b32 exec_hi, 0x80000000
    ds_write_b128 v108, v[128:131]
    ds_write_b128 v108, v[132:135] offset:16
    s_mov_b64 exec, -1
    s_waitcnt vmcnt(15)
    ds_write_b128 v110, v[88:91]
    s_waitcnt vmcnt(14)
    ds_write_b128 v110, v[92:95] offset:5120
    s_waitcnt vmcnt(13)
    ds_write_b128 v110, v[96:99] offset:10240
    s_waitcnt vmcnt(12)
    ds_write_b128 v110, v[100:103] offset:15360
    s_waitcnt lgkmcnt(0)
    s_barrier
    ds_read_b32 v128, v109
    ds_read_b64_tr_b16 v[80:81], v114 offset:0
    ds_read_b64_tr_b16 v[82:83], v114 offset:640
    ds_read_b64_tr_b16 v[84:85], v114 offset:5120
    ds_read_b64_tr_b16 v[86:87], v114 offset:5760
    ds_read_b64_tr_b16 v[88:89], v115 offset:10240
    ds_read_b64_tr_b16 v[90:91], v116 offset:10240
    ds_read_b64_tr_b16 v[92:93], v115 offset:15360
    ds_read_b64_tr_b16 v[94:95], v116 offset:15360
    s_cmp_eq_u32 s12, 0
    s_cselect_b32 s18, 0, 1073741824
    v_add_u32 v108, s18, v125
    s_mov_b32 exec_hi, 0
    s_waitcnt lgkmcnt(8)
    buffer_store_dword v128, v108, s[4:7], s40 offen sc1
    s_mov_b64 exec, -1
    s_waitcnt lgkmcnt(6)
    buffer_store_dwordx4 v[80:83], v117, s[4:7], s41 offen sc1
    s_waitcnt lgkmcnt(4)
    buffer_store_dwordx4 v[84:87], v117, s[4:7], s44 offen sc1
    s_waitcnt lgkmcnt(2)
    buffer_store_dwordx4 v[88:91], v4, s[4:7], s42 offen sc1
    s_waitcnt lgkmcnt(0)
    buffer_store_dwordx4 v[92:95], v4, s[4:7], s43 offen sc1
    v_mfma_f32_16x16x32_bf16 v[96:99], v[16:19], v[88:91], 0
    v_mfma_f32_16x16x32_bf16 v[96:99], v[16:19], v[92:95], v[96:99]
    s_waitcnt vmcnt(9)
    v_mov_b32 v66, v79
    s_waitcnt vmcnt(8)
    v_add_u32 v65, 0x9e3779b9, v65
    s_nop 0
    v_readfirstlane_b32 s45, v65
    s_mov_b64 exec, 0xffff
    s_nop 0
    buffer_store_dword v96, v125, s[4:7], s46 offen sc1
    s_mov_b64 exec, -1
    v_mul_f32 v78, 0x3fb8aa3b, v78
    v_exp_f32 v78, v78
    s_nop 0
    v_cvt_pk_bf16_f32 v78, v78, v78
    v_and_b32 v78, 0xffff0000, v78
    v_mul_f32 v72, v78, v72
    v_mul_f32 v73, v78, v73
    v_mul_f32 v74, v78, v74
    v_mul_f32 v75, v78, v75
    v_mul_f32 v72, 0x3fb8aa3b, v72
    v_mul_f32 v73, 0x3e22f983, v73
    v_pk_mul_f32 v[128:129], v[76:77], v[74:75] op_sel_hi:[1,0]
    v_pk_fma_f32 v[128:129], v[76:77], v[74:75], v[128:129] op_sel:[1,1,0] op_sel_hi:[0,1,1] neg_lo:[1,0,0]
    v_mul_f32 v112, 0x41000000, v72
    v_mul_f32 v114, 0x3f800000, v72
    v_mul_f32 v116, 0x43800000, v72
    v_mul_f32 v113, 0xc1000000, v73
    v_mul_f32 v115, 0x3f800000, v73
    v_mul_f32 v117, 0x43800000, v73
    v_exp_f32 v112, v112
    v_exp_f32 v114, v114
    v_exp_f32 v116, v116
    v_fract_f32 v113, v113
    v_fract_f32 v115, v115
    v_fract_f32 v117, v117
    v_cos_f32 v186, v113
    v_cos_f32 v68, v115
    v_cos_f32 v70, v117
    v_sin_f32 v187, v113
    v_sin_f32 v69, v115
    v_sin_f32 v71, v117
    v_mul_f32 v186, v112, v186
    v_mul_f32 v68, v114, v68
    v_mul_f32 v70, v116, v70
    v_mul_f32 v187, v112, v187
    v_mul_f32 v69, v114, v69
    v_mul_f32 v71, v116, v71
    v_mov_b32 v184, 1.0
    v_mov_b32 v185, 0
    v_pk_mul_f32 v[188:189], v[186:187], v[186:187] op_sel_hi:[1,0]
    v_pk_fma_f32 v[188:189], v[186:187], v[186:187], v[188:189] op_sel:[1,1,0] op_sel_hi:[0,1,1] neg_lo:[1,0,0]
    v_pk_mul_f32 v[130:131], v[128:129], v[68:69] op_sel_hi:[1,0]
    v_pk_mul_f32 v[192:193], v[188:189], v[188:189] op_sel_hi:[1,0]
    v_pk_mul_f32 v[190:191], v[186:187], v[188:189] op_sel_hi:[1,0]
    v_pk_fma_f32 v[130:131], v[128:129], v[68:69], v[130:131] op_sel:[1,1,0] op_sel_hi:[0,1,1] neg_lo:[1,0,0]
    v_pk_fma_f32 v[192:193], v[188:189], v[188:189], v[192:193] op_sel:[1,1,0] op_sel_hi:[0,1,1] neg_lo:[1,0,0]
    v_pk_fma_f32 v[190:191], v[186:187], v[188:189], v[190:191] op_sel:[1,1,0] op_sel_hi:[0,1,1] neg_lo:[1,0,0]
    v_pk_mul_f32 v[146:147], v[128:129], v[70:71] op_sel_hi:[1,0]
    v_pk_mul_f32 v[196:197], v[192:193], v[188:189] op_sel_hi:[1,0]
    v_pk_mul_f32 v[194:195], v[190:191], v[188:189] op_sel_hi:[1,0]
    v_pk_fma_f32 v[146:147], v[128:129], v[70:71], v[146:147] op_sel:[1,1,0] op_sel_hi:[0,1,1] neg_lo:[1,0,0]
    v_pk_fma_f32 v[196:197], v[192:193], v[188:189], v[196:197] op_sel:[1,1,0] op_sel_hi:[0,1,1] neg_lo:[1,0,0]
    v_pk_fma_f32 v[194:195], v[190:191], v[188:189], v[194:195] op_sel:[1,1,0] op_sel_hi:[0,1,1] neg_lo:[1,0,0]
    v_pk_mul_f32 v[132:133], v[130:131], v[68:69] op_sel_hi:[1,0]
    v_pk_mul_f32 v[198:199], v[194:195], v[188:189] op_sel_hi:[1,0]
    v_pk_fma_f32 v[132:133], v[130:131], v[68:69], v[132:133] op_sel:[1,1,0] op_sel_hi:[0,1,1] neg_lo:[1,0,0]
    v_pk_fma_f32 v[198:199], v[194:195], v[188:189], v[198:199] op_sel:[1,1,0] op_sel_hi:[0,1,1] neg_lo:[1,0,0]
    v_pk_mul_f32 v[148:149], v[132:133], v[70:71] op_sel_hi:[1,0]
    v_pk_fma_f32 v[148:149], v[132:133], v[70:71], v[148:149] op_sel:[1,1,0] op_sel_hi:[0,1,1] neg_lo:[1,0,0]
    v_pk_mul_f32 v[134:135], v[132:133], v[68:69] op_sel_hi:[1,0]
    v_pk_fma_f32 v[134:135], v[132:133], v[68:69], v[134:135] op_sel:[1,1,0] op_sel_hi:[0,1,1] neg_lo:[1,0,0]
    v_pk_mul_f32 v[136:137], v[134:135], v[68:69] op_sel_hi:[1,0]
    v_pk_fma_f32 v[136:137], v[134:135], v[68:69], v[136:137] op_sel:[1,1,0] op_sel_hi:[0,1,1] neg_lo:[1,0,0]
    v_pk_mul_f32 v[150:151], v[136:137], v[70:71] op_sel_hi:[1,0]
    v_pk_fma_f32 v[150:151], v[136:137], v[70:71], v[150:151] op_sel:[1,1,0] op_sel_hi:[0,1,1] neg_lo:[1,0,0]
    v_cvt_pk_bf16_f32 v96, v184, v186
    v_cvt_pk_bf16_f32 v97, v188, v190
    v_cvt_pk_bf16_f32 v98, v192, v194
    v_cvt_pk_bf16_f32 v99, v196, v198
    ds_write_b128 v120, v[96:99] offset:9216
    v_cvt_pk_bf16_f32 v100, v185, v187
    v_cvt_pk_bf16_f32 v101, v189, v191
    v_cvt_pk_bf16_f32 v102, v193, v195
    v_cvt_pk_bf16_f32 v103, v197, v199
    ds_write_b128 v120, v[100:103] offset:9280
    v_cvt_pk_bf16_f32 v104, v128, v130
    v_cvt_pk_bf16_f32 v105, v132, v134
    v_cvt_pk_bf16_f32 v106, v146, v146
    v_cvt_pk_bf16_f32 v107, v148, v150
    ds_write_b128 v120, v[104:107] offset:0
    v_cvt_pk_bf16_f32 v108, v129, v131
    v_cvt_pk_bf16_f32 v109, v133, v135
    v_cvt_pk_bf16_f32 v110, v147, v147
    v_cvt_pk_bf16_f32 v111, v149, v151
    ds_write_b128 v120, v[108:111] offset:64
    s_mov_b64 exec, 0
    s_cmp_eq_u32 s12, 0
    s_cbranch_scc1 iw1
    s_cmp_eq_u32 s12, 1
    s_cbranch_scc1 iw2
    s_cmp_eq_u32 s12, 2
    s_cbranch_scc1 iw3
    s_branch iw4
iw_back:
    s_mov_b64 exec, -1
    s_waitcnt vmcnt(0)
    v_mov_b32 v252, 105984
    v_mov_b32 v253, 1
    s_mov_b64 exec, 1
    ds_add_rtn_u32 v253, v252, v253
    s_mov_b64 exec, -1
    s_add_u32 s62, s72, 0
    s_waitcnt lgkmcnt(0)
    v_readfirstlane_b32 s61, v253
    s_nop 3
    s_and_b32 s61, s61, 3
    s_cmp_lg_u32 s61, 3
    s_cbranch_scc1 ar1
    buffer_store_dword v65, v62, s[4:7], s62 offen sc1
ar1:
    v_pk_mul_f32 v[138:139], v[136:137], v[68:69] op_sel_hi:[1,0]
    v_pk_mul_f32 v[200:201], v[196:197], v[188:189] op_sel_hi:[1,0]
    v_pk_mul_f32 v[202:203], v[198:199], v[188:189] op_sel_hi:[1,0]
    v_pk_fma_f32 v[138:139], v[136:137], v[68:69], v[138:139] op_sel:[1,1,0] op_sel_hi:[0,1,1] neg_lo:[1,0,0]
    v_pk_fma_f32 v[200:201], v[196:197], v[188:189], v[200:201] op_sel:[1,1,0] op_sel_hi:[0,1,1] neg_lo:[1,0,0]
    v_pk_fma_f32 v[202:203], v[198:199], v[188:189], v[202:203] op_sel:[1,1,0] op_sel_hi:[0,1,1] neg_lo:[1,0,0]
    v_pk_mul_f32 v[140:141], v[138:139], v[68:69] op_sel_hi:[1,0]
    v_pk_mul_f32 v[204:205], v[200:201], v[188:189] op_sel_hi:[1,0]
    v_pk_mul_f32 v[206:207], v[202:203], v[188:189] op_sel_hi:[1,0]
    v_pk_fma_f32 v[140:141], v[138:139], v[68:69], v[140:141] op_sel:[1,1,0] op_sel_hi:[0,1,1] neg_lo:[1,0,0]
    v_pk_fma_f32 v[204:205], v[200:201], v[188:189], v[204:205] op_sel:[1,1,0] op_sel_hi:[0,1,1] neg_lo:[1,0,0]
    v_pk_fma_f32 v[206:207], v[202:203], v[188:189], v[206:207] op_sel:[1,1,0] op_sel_hi:[0,1,1] neg_lo:[1,0,0]
    v_pk_mul_f32 v[152:153], v[140:141], v[70:71] op_sel_hi:[1,0]
    v_pk_mul_f32 v[208:209], v[204:205], v[188:189] op_sel_hi:[1,0]
    v_pk_mul_f32 v[210:211], v[206:207], v[188:189] op_sel_hi:[1,0]
    v_pk_fma_f32 v[152:153], v[140:141], v[70:71], v[152:153] op_sel:[1,1,0] op_sel_hi:[0,1,1] neg_lo:[1,0,0]
    v_pk_fma_f32 v[208:209], v[204:205], v[188:189], v[208:209] op_sel:[1,1,0] op_sel_hi:[0,1,1] neg_lo:[1,0,0]
    v_pk_fma_f32 v[210:211], v[206:207], v[188:189], v[210:211] op_sel:[1,1,0] op_sel_hi:[0,1,1] neg_lo:[1,0,0]
    v_pk_mul_f32 v[142:143], v[140:141], v[68:69] op_sel_hi:[1,0]
    v_pk_mul_f32 v[212:213], v[208:209], v[188:189] op_sel_hi:[1,0]
    v_pk_mul_f32 v[214:215], v[210:211], v[188:189] op_sel_hi:[1,0]
    v_pk_fma_f32 v[142:143], v[140:141], v[68:69], v[142:143] op_sel:[1,1,0] op_sel_hi:[0,1,1] neg_lo:[1,0,0]
    v_pk_fma_f32 v[212:213], v[208:209], v[188:189], v[212:213] op_sel:[1,1,0] op_sel_hi:[0,1,1] neg_lo:[1,0,0]
    v_pk_fma_f32 v[214:215], v[210:211], v[188:189], v[214:215] op_sel:[1,1,0] op_sel_hi:[0,1,1] neg_lo:[1,0,0]
    v_pk_mul_f32 v[144:145], v[142:143], v[68:69] op_sel_hi:[1,0]
    v_pk_fma_f32 v[144:145], v[142:143], v[68:69], v[144:145] op_sel:[1,1,0] op_sel_hi:[0,1,1] neg_lo:[1,0,0]
    v_pk_mul_f32 v[154:155], v[144:145], v[70:71] op_sel_hi:[1,0]
    v_pk_fma_f32 v[154:155], v[144:145], v[70:71], v[154:155] op_sel:[1,1,0] op_sel_hi:[0,1,1] neg_lo:[1,0,0]
    v_pk_mul_f32 v[156:157], v[146:147], v[70:71] op_sel_hi:[1,0]
    v_pk_fma_f32 v[156:157], v[146:147], v[70:71], v[156:157] op_sel:[1,1,0] op_sel_hi:[0,1,1] neg_lo:[1,0,0]
    v_cvt_pk_bf16_f32 v96, v200, v202
    v_cvt_pk_bf16_f32 v97, v204, v206
    v_cvt_pk_bf16_f32 v98, v208, v210
    v_cvt_pk_bf16_f32 v99, v212, v214
    ds_write_b128 v120, v[96:99] offset:9232
    v_cvt_pk_bf16_f32 v100, v201, v203
    v_cvt_pk_bf16_f32 v101, v205, v207
    v_cvt_pk_bf16_f32 v102, v209, v211
    v_cvt_pk_bf16_f32 v103, v213, v215
    ds_write_b128 v120, v[100:103] offset:9296
    v_cvt_pk_bf16_f32 v104, v136, v138
    v_cvt_pk_bf16_f32 v105, v140, v142
    v_cvt_pk_bf16_f32 v106, v150, v150
    v_cvt_pk_bf16_f32 v107, v152, v154
    ds_write_b128 v120, v[104:107] offset:16
    v_cvt_pk_bf16_f32 v108, v137, v139
    v_cvt_pk_bf16_f32 v109, v141, v143
    v_cvt_pk_bf16_f32 v110, v151, v151
    v_cvt_pk_bf16_f32 v111, v153, v155
    ds_write_b128 v120, v[108:111] offset:80
    v_pk_mul_f32 v[158:159], v[150:151], v[70:71] op_sel_hi:[1,0]
    v_pk_mul_f32 v[216:217], v[212:213], v[188:189] op_sel_hi:[1,0]
    v_pk_mul_f32 v[218:219], v[214:215], v[188:189] op_sel_hi:[1,0]
    v_pk_fma_f32 v[158:159], v[150:151], v[70:71], v[158:159] op_sel:[1,1,0] op_sel_hi:[0,1,1] neg_lo:[1,0,0]
    v_pk_fma_f32 v[216:217], v[212:213], v[188:189], v[216:217] op_sel:[1,1,0] op_sel_hi:[0,1,1] neg_lo:[1,0,0]
    v_pk_fma_f32 v[218:219], v[214:215], v[188:189], v[218:219] op_sel:[1,1,0] op_sel_hi:[0,1,1] neg_lo:[1,0,0]
    v_pk_mul_f32 v[160:161], v[154:155], v[70:71] op_sel_hi:[1,0]
    v_pk_mul_f32 v[220:221], v[216:217], v[188:189] op_sel_hi:[1,0]
    v_pk_mul_f32 v[222:223], v[218:219], v[188:189] op_sel_hi:[1,0]
    v_pk_fma_f32 v[160:161], v[154:155], v[70:71], v[160:161] op_sel:[1,1,0] op_sel_hi:[0,1,1] neg_lo:[1,0,0]
    v_pk_fma_f32 v[220:221], v[216:217], v[188:189], v[220:221] op_sel:[1,1,0] op_sel_hi:[0,1,1] neg_lo:[1,0,0]
    v_pk_fma_f32 v[222:223], v[218:219], v[188:189], v[222:223] op_sel:[1,1,0] op_sel_hi:[0,1,1] neg_lo:[1,0,0]
    v_pk_mul_f32 v[162:163], v[156:157], v[70:71] op_sel_hi:[1,0]
    v_pk_mul_f32 v[224:225], v[220:221], v[188:189] op_sel_hi:[1,0]
    v_pk_mul_f32 v[226:227], v[222:223], v[188:189] op_sel_hi:[1,0]
    v_pk_fma_f32 v[162:163], v[156:157], v[70:71], v[162:163] op_sel:[1,1,0] op_sel_hi:[0,1,1] neg_lo:[1,0,0]
    v_pk_fma_f32 v[224:225], v[220:221], v[188:189], v[224:225] op_sel:[1,1,0] op_sel_hi:[0,1,1] neg_lo:[1,0,0]
    v_pk_fma_f32 v[226:227], v[222:223], v[188:189], v[226:227] op_sel:[1,1,0] op_sel_hi:[0,1,1] neg_lo:[1,0,0]
    v_pk_mul_f32 v[164:165], v[158:159], v[70:71] op_sel_hi:[1,0]
    v_pk_mul_f32 v[228:229], v[224:225], v[188:189] op_sel_hi:[1,0]
    v_pk_mul_f32 v[230:231], v[226:227], v[188:189] op_sel_hi:[1,0]
    v_pk_fma_f32 v[164:165], v[158:159], v[70:71], v[164:165] op_sel:[1,1,0] op_sel_hi:[0,1,1] neg_lo:[1,0,0]
    v_pk_fma_f32 v[228:229], v[224:225], v[188:189], v[228:229] op_sel:[1,1,0] op_sel_hi:[0,1,1] neg_lo:[1,0,0]
    v_pk_fma_f32 v[230:231], v[226:227], v[188:189], v[230:231] op_sel:[1,1,0] op_sel_hi:[0,1,1] neg_lo:[1,0,0]
    v_pk_mul_f32 v[166:167], v[160:161], v[70:71] op_sel_hi:[1,0]
    v_pk_fma_f32 v[166:167], v[160:161], v[70:71], v[166:167] op_sel:[1,1,0] op_sel_hi:[0,1,1] neg_lo:[1,0,0]
    v_pk_mul_f32 v[168:169], v[162:163], v[70:71] op_sel_hi:[1,0]
    v_pk_fma_f32 v[168:169], v[162:163], v[70:71], v[168:169] op_sel:[1,1,0] op_sel_hi:[0,1,1] neg_lo:[1,0,0]
    v_pk_mul_f32 v[170:171], v[166:167], v[70:71] op_sel_hi:[1,0]
    v_pk_fma_f32 v[170:171], v[166:167], v[70:71], v[170:171] op_sel:[1,1,0] op_sel_hi:[0,1,1] neg_lo:[1,0,0]
    v_cvt_pk_bf16_f32 v96, v216, v218
    v_cvt_pk_bf16_f32 v97, v220, v222
    v_cvt_pk_bf16_f32 v98, v224, v226
    v_cvt_pk_bf16_f32 v99, v228, v230
    ds_write_b128 v120, v[96:99] offset:9248
    v_cvt_pk_bf16_f32 v100, v217, v219
    v_cvt_pk_bf16_f32 v101, v221, v223
    v_cvt_pk_bf16_f32 v102, v225, v227
    v_cvt_pk_bf16_f32 v103, v229, v231
    ds_write_b128 v120, v[100:103] offset:9312
    v_cvt_pk_bf16_f32 v104, v144, v156
    v_cvt_pk_bf16_f32 v105, v158, v160
    v_cvt_pk_bf16_f32 v106, v154, v162
    v_cvt_pk_bf16_f32 v107, v164, v166
    ds_write_b128 v120, v[104:107] offset:32
    v_cvt_pk_bf16_f32 v108, v145, v157
    v_cvt_pk_bf16_f32 v109, v159, v161
    v_cvt_pk_bf16_f32 v110, v155, v163
    v_cvt_pk_bf16_f32 v111, v165, v167
    ds_write_b128 v120, v[108:111] offset:96
    v_pk_mul_f32 v[172:173], v[168:169], v[70:71] op_sel_hi:[1,0]
    v_pk_mul_f32 v[232:233], v[228:229], v[188:189] op_sel_hi:[1,0]
    v_pk_mul_f32 v[234:235], v[230:231], v[188:189] op_sel_hi:[1,0]
    v_pk_fma_f32 v[172:173], v[168:169], v[70:71], v[172:173] op_sel:[1,1,0] op_sel_hi:[0,1,1] neg_lo:[1,0,0]
    v_pk_fma_f32 v[232:233], v[228:229], v[188:189], v[232:233] op_sel:[1,1,0] op_sel_hi:[0,1,1] neg_lo:[1,0,0]
    v_pk_fma_f32 v[234:235], v[230:231], v[188:189], v[234:235] op_sel:[1,1,0] op_sel_hi:[0,1,1] neg_lo:[1,0,0]
    v_pk_mul_f32 v[174:175], v[170:171], v[70:71] op_sel_hi:[1,0]
    v_pk_mul_f32 v[236:237], v[232:233], v[188:189] op_sel_hi:[1,0]
    v_pk_mul_f32 v[238:239], v[234:235], v[188:189] op_sel_hi:[1,0]
    v_pk_fma_f32 v[174:175], v[170:171], v[70:71], v[174:175] op_sel:[1,1,0] op_sel_hi:[0,1,1] neg_lo:[1,0,0]
    v_pk_fma_f32 v[236:237], v[232:233], v[188:189], v[236:237] op_sel:[1,1,0] op_sel_hi:[0,1,1] neg_lo:[1,0,0]
    v_pk_fma_f32 v[238:239], v[234:235], v[188:189], v[238:239] op_sel:[1,1,0] op_sel_hi:[0,1,1] neg_lo:[1,0,0]
    v_pk_mul_f32 v[176:177], v[172:173], v[70:71] op_sel_hi:[1,0]
    v_pk_mul_f32 v[240:241], v[236:237], v[188:189] op_sel_hi:[1,0]
    v_pk_mul_f32 v[242:243], v[238:239], v[188:189] op_sel_hi:[1,0]
    v_pk_fma_f32 v[176:177], v[172:173], v[70:71], v[176:177] op_sel:[1,1,0] op_sel_hi:[0,1,1] neg_lo:[1,0,0]
    v_pk_fma_f32 v[240:241], v[236:237], v[188:189], v[240:241] op_sel:[1,1,0] op_sel_hi:[0,1,1] neg_lo:[1,0,0]
    v_pk_fma_f32 v[242:243], v[238:239], v[188:189], v[242:243] op_sel:[1,1,0] op_sel_hi:[0,1,1] neg_lo:[1,0,0]
    v_pk_mul_f32 v[178:179], v[174:175], v[70:71] op_sel_hi:[1,0]
    v_pk_mul_f32 v[244:245], v[240:241], v[188:189] op_sel_hi:[1,0]
    v_pk_mul_f32 v[246:247], v[242:243], v[188:189] op_sel_hi:[1,0]
    v_pk_fma_f32 v[178:179], v[174:175], v[70:71], v[178:179] op_sel:[1,1,0] op_sel_hi:[0,1,1] neg_lo:[1,0,0]
    v_pk_fma_f32 v[244:245], v[240:241], v[188:189], v[244:245] op_sel:[1,1,0] op_sel_hi:[0,1,1] neg_lo:[1,0,0]
    v_pk_fma_f32 v[246:247], v[242:243], v[188:189], v[246:247] op_sel:[1,1,0] op_sel_hi:[0,1,1] neg_lo:[1,0,0]
    v_pk_mul_f32 v[180:181], v[176:177], v[70:71] op_sel_hi:[1,0]
    v_pk_fma_f32 v[180:181], v[176:177], v[70:71], v[180:181] op_sel:[1,1,0] op_sel_hi:[0,1,1] neg_lo:[1,0,0]
    v_pk_mul_f32 v[182:183], v[178:179], v[70:71] op_sel_hi:[1,0]
    v_pk_fma_f32 v[182:183], v[178:179], v[70:71], v[182:183] op_sel:[1,1,0] op_sel_hi:[0,1,1] neg_lo:[1,0,0]
    v_cvt_pk_bf16_f32 v96, v232, v234
    v_cvt_pk_bf16_f32 v97, v236, v238
    v_cvt_pk_bf16_f32 v98, v240, v242
    v_cvt_pk_bf16_f32 v99, v244, v246
    ds_write_b128 v120, v[96:99] offset:9264
    v_cvt_pk_bf16_f32 v100, v233, v235
    v_cvt_pk_bf16_f32 v101, v237, v239
    v_cvt_pk_bf16_f32 v102, v241, v243
    v_cvt_pk_bf16_f32 v103, v245, v247
    ds_write_b128 v120, v[100:103] offset:9328
    v_cvt_pk_bf16_f32 v104, v168, v170
    v_cvt_pk_bf16_f32 v105, v176, v178
    v_cvt_pk_bf16_f32 v106, v172, v174
    v_cvt_pk_bf16_f32 v107, v180, v182
    ds_write_b128 v120, v[104:107] offset:48
    v_cvt_pk_bf16_f32 v108, v169, v171
    v_cvt_pk_bf16_f32 v109, v177, v179
    v_cvt_pk_bf16_f32 v110, v173, v175
    v_cvt_pk_bf16_f32 v111, v181, v183
    ds_write_b128 v120, v[108:111] offset:112
    s_add_u32 s46, s67, 0
    ds_read_b64_tr_b16 v[128:129], v121 offset:0
    ds_read_b64_tr_b16 v[160:161], v121 offset:9216
    ds_read_b64_tr_b16 v[130:131], v121 offset:144
    ds_read_b64_tr_b16 v[162:163], v121 offset:9360
    ds_read_b64_tr_b16 v[132:133], v121 offset:576
    ds_read_b64_tr_b16 v[164:165], v121 offset:9792
    ds_read_b64_tr_b16 v[134:135], v121 offset:720
    ds_read_b64_tr_b16 v[166:167], v121 offset:9936
    ds_read_b64_tr_b16 v[136:137], v121 offset:2304
    ds_read_b64_tr_b16 v[168:169], v121 offset:11520
    ds_read_b64_tr_b16 v[138:139], v121 offset:2448
    ds_read_b64_tr_b16 v[170:171], v121 offset:11664
    s_waitcnt lgkmcnt(8)
    v_mfma_f32_32x32x16_bf16 v[192:207], v[128:131], v[160:163], 0
    ds_read_b64_tr_b16 v[140:141], v121 offset:2880
    ds_read_b64_tr_b16 v[172:173], v121 offset:12096
    ds_read_b64_tr_b16 v[142:143], v121 offset:3024
    ds_read_b64_tr_b16 v[174:175], v121 offset:12240
    s_waitcnt lgkmcnt(8)
    v_mfma_f32_32x32x16_bf16 v[192:207], v[132:135], v[164:167], v[192:207]
    ds_read_b64_tr_b16 v[144:145], v121 offset:4608
    ds_read_b64_tr_b16 v[176:177], v121 offset:13824
    ds_read_b64_tr_b16 v[146:147], v121 offset:4752
    ds_read_b64_tr_b16 v[178:179], v121 offset:13968
    s_waitcnt lgkmcnt(8)
    v_mfma_f32_32x32x16_bf16 v[192:207], v[136:139], v[168:171], v[192:207]
    ds_read_b64_tr_b16 v[148:149], v121 offset:5184
    ds_read_b64_tr_b16 v[180:181], v121 offset:14400
    ds_read_b64_tr_b16 v[150:151], v121 offset:5328
    ds_read_b64_tr_b16 v[182:183], v121 offset:14544
    s_waitcnt lgkmcnt(8)
    v_mfma_f32_32x32x16_bf16 v[192:207], v[140:143], v[172:175], v[192:207]
    ds_read_b64_tr_b16 v[152:153], v121 offset:6912
    ds_read_b64_tr_b16 v[184:185], v121 offset:16128
    ds_read_b64_tr_b16 v[154:155], v121 offset:7056
    ds_read_b64_tr_b16 v[186:187], v121 offset:16272
    s_waitcnt lgkmcnt(8)
    v_mfma_f32_32x32x16_bf16 v[192:207], v[144:147], v[176:179], v[192:207]
    ds_read_b64_tr_b16 v[156:157], v121 offset:7488
    ds_read_b64_tr_b16 v[188:189], v121 offset:16704
    ds_read_b64_tr_b16 v[158:159], v121 offset:7632
    ds_read_b64_tr_b16 v[190:191], v121 offset:16848
    s_waitcnt lgkmcnt(8)
    v_mfma_f32_32x32x16_bf16 v[192:207], v[148:151], v[180:183], v[192:207]
    s_waitcnt lgkmcnt(4)
    v_mfma_f32_32x32x16_bf16 v[192:207], v[152:155], v[184:187], v[192:207]
    s_waitcnt lgkmcnt(0)
    v_mfma_f32_32x32x16_bf16 v[192:207], v[156:159], v[188:191], v[192:207]
    v_and_b32 v126, 1, v1
    v_cmp_eq_u32 vcc, 0, v126
    s_nop 9
    ds_write_b128 v122, v[192:195] offset:0
    ds_write_b128 v122, v[196:199] offset:1024
    ds_write_b128 v122, v[200:203] offset:2048
    ds_write_b128 v122, v[204:207] offset:3072
    s_waitcnt lgkmcnt(0)
    s_barrier
    ds_read_b128 v[208:211], v123 offset:0
    ds_read_b128 v[212:215], v123 offset:1024
    ds_read_b128 v[216:219], v123 offset:2048
    ds_read_b128 v[220:223], v123 offset:3072
    s_waitcnt lgkmcnt(3)
    v_add_f32 v192, v192, v208
    v_add_f32 v193, v193, v209
    v_add_f32 v194, v194, v210
    v_add_f32 v195, v195, v211
    s_waitcnt lgkmcnt(2)
    v_add_f32 v196, v196, v212
    v_add_f32 v197, v197, v213
    v_add_f32 v198, v198, v214
    v_add_f32 v199, v199, v215
    s_waitcnt lgkmcnt(1)
    v_add_f32 v200, v200, v216
    v_add_f32 v201, v201, v217
    v_add_f32 v202, v202, v218
    v_add_f32 v203, v203, v219
    s_waitcnt lgkmcnt(0)
    v_add_f32 v204, v204, v220
    v_add_f32 v205, v205, v221
    v_add_f32 v206, v206, v222
    v_add_f32 v207, v207, v223
    v_cndmask_b32 v224, v205, v204, vcc
    v_cndmask_b32 v225, v207, v206, vcc
    buffer_load_dword v250, v61, s[4:7], s46 offen sc1
    s_bitcmp1_b32 s12, 0
    s_cbranch_scc1 kg_copy1
    v_cvt_pk_bf16_f32 v80, v192, v193
    v_cvt_pk_bf16_f32 v81, v194, v195
    v_cvt_pk_bf16_f32 v82, v196, v197
    v_cvt_pk_bf16_f32 v83, v198, v199
    v_cvt_pk_bf16_f32 v84, v201, v201
    v_cvt_pk_bf16_f32 v85, v201, v202
    v_cvt_pk_bf16_f32 v86, v202, v202
    v_cvt_pk_bf16_f32 v87, v203, v203
    v_cvt_pk_bf16_f32 v88, v204, v204
    v_cvt_pk_bf16_f32 v89, v204, v204
    v_cvt_pk_bf16_f32 v90, v224, v205
    v_cvt_pk_bf16_f32 v91, v205, v205
    v_cvt_pk_bf16_f32 v92, v206, v206
    v_cvt_pk_bf16_f32 v93, v206, v206
    v_cvt_pk_bf16_f32 v94, v225, v207
    v_cvt_pk_bf16_f32 v95, v207, v207
    s_branch kg_st
kg_copy1:
    v_cvt_pk_bf16_f32 v80, v193, v194
    v_cvt_pk_bf16_f32 v81, v195, v196
    v_cvt_pk_bf16_f32 v82, v197, v198
    v_cvt_pk_bf16_f32 v83, v199, v200
    v_cvt_pk_bf16_f32 v84, v201, v201
    v_cvt_pk_bf16_f32 v85, v202, v202
    v_cvt_pk_bf16_f32 v86, v202, v203
    v_cvt_pk_bf16_f32 v87, v203, v203
    v_cvt_pk_bf16_f32 v88, v204, v204
    v_cvt_pk_bf16_f32 v89, v204, v224
    v_cvt_pk_bf16_f32 v90, v205, v205
    v_cvt_pk_bf16_f32 v91, v205, v205
    v_cvt_pk_bf16_f32 v92, v206, v206
    v_cvt_pk_bf16_f32 v93, v206, v225
    v_cvt_pk_bf16_f32 v94, v207, v207
    v_cvt_pk_bf16_f32 v95, v207, v207
    v_cvt_pk_bf16_f32 v126, v192, v192
    s_mov_b64 exec, 1
    ds_write_b16 v124, v126 offset:30
    s_mov_b64 exec, -1
kg_st:
    ds_write_b128 v124, v[80:83] offset:32
    ds_write_b128 v124, v[84:87] offset:1056
    ds_write_b128 v124, v[88:91] offset:2080
    ds_write_b128 v124, v[92:95] offset:3104
    s_waitcnt lgkmcnt(0)
    s_barrier
    v_mov_b32 v254, s29
    s_waitcnt vmcnt(0)
    v_cmp_ne_u32 vcc, s45, v250
    s_cbranch_vccnz ps2
pe2:
    s_mov_b32 s18, 14680064
    s_lshl_b32 s23, s15, 5
    s_add_u32 s23, s23, 0
    buffer_load_dwordx4 v[216:219], v6, s[4:7], s18 offen offset:0 sc1
    buffer_load_dwordx4 v[220:223], v6, s[4:7], s18 offen offset:1024 sc1
    buffer_load_dwordx4 v[224:227], v6, s[4:7], s18 offen offset:2048 sc1
    buffer_load_dwordx4 v[228:231], v6, s[4:7], s18 offen offset:3072 sc1
    buffer_load_dwordx4 v[212:215], v248, s[4:7], s23 offen sc1
    s_barrier
    s_cmp_lg_u32 s2, 0
    s_cbranch_scc1 tag_done
    s_mov_b32 s19, 14811136
    buffer_store_dword v65, v63, s[4:7], s19 offen sc1
tag_done:
    v_and_b32 v252, 7, v1
    v_lshlrev_b32 v252, 13, v252
    v_lshl_add_u32 v252, v3, 4, v252
    v_lshlrev_b32 v253, 14, v3
    v_lshl_add_u32 v253, v2, 2, v253
    s_lshl_b32 s20, s31, 6
    s_add_u32 s20, s20, 14745600
    s_add_u32 s21, s20, 4096
    s_add_u32 s60, s21, 8192
    buffer_load_dwordx4 v[20:23], v252, s[4:7], s20 offen sc1
    buffer_load_dwordx4 v[24:27], v252, s[4:7], s20 offen offset:2048 sc1
    buffer_load_dword v28, v253, s[4:7], s21 offen sc1
    buffer_load_dword v29, v253, s[4:7], s60 offen sc1
    s_add_u32 s32, s34, 0
    buffer_load_dwordx4 a[0:3], v4, s[4:7], s32 offen offset:0
    ds_read2_b32 v[68:69], v8 offset0:0 offset1:1
    ds_read2_b32 v[70:71], v8 offset0:2 offset1:3
    ds_read2_b32 v[72:73], v8 offset0:128 offset1:129
    ds_read2_b32 v[74:75], v8 offset0:130 offset1:131
    buffer_load_dwordx4 a[4:7], v4, s[4:7], s32 offen offset:1024
    ds_read2_b32 v[76:77], v9 offset0:0 offset1:1
    ds_read2_b32 v[78:79], v9 offset0:2 offset1:3
    ds_read2_b32 v[80:81], v9 offset0:128 offset1:129
    ds_read2_b32 v[82:83], v9 offset0:130 offset1:131
    buffer_load_dwordx4 a[8:11], v4, s[4:7], s32 offen offset:2048
    ds_read2_b32 v[84:85], v8 offset0:16 offset1:17
    ds_read2_b32 v[86:87], v8 offset0:18 offset1:19
    ds_read2_b32 v[88:89], v8 offset0:144 offset1:145
    ds_read2_b32 v[90:91], v8 offset0:146 offset1:147
    s_add_u32 s32, s34, 131072
    buffer_load_dwordx4 a[12:15], v4, s[4:7], s32 offen offset:0
    ds_read2_b32 v[92:93], v9 offset0:16 offset1:17
    ds_read2_b32 v[94:95], v9 offset0:18 offset1:19
    ds_read2_b32 v[96:97], v9 offset0:144 offset1:145
    ds_read2_b32 v[98:99], v9 offset0:146 offset1:147
    buffer_load_dwordx4 a[16:19], v4, s[4:7], s32 offen offset:1024
    ds_read2_b32 v[100:101], v8 offset0:32 offset1:33
    ds_read2_b32 v[102:103], v8 offset0:34 offset1:35
    ds_read2_b32 v[104:105], v8 offset0:160 offset1:161
    ds_read2_b32 v[106:107], v8 offset0:162 offset1:163
    buffer_load_dwordx4 a[20:23], v4, s[4:7], s32 offen offset:2048
    ds_read2_b32 v[108:109], v9 offset0:32 offset1:33
    ds_read2_b32 v[110:111], v9 offset0:34 offset1:35
    ds_read2_b32 v[112:113], v9 offset0:160 offset1:161
    ds_read2_b32 v[114:115], v9 offset0:162 offset1:163
    s_add_u32 s32, s34, 262144
    buffer_load_dwordx4 a[24:27], v4, s[4:7], s32 offen offset:0
    ds_read2_b32 v[116:117], v8 offset0:48 offset1:49
    ds_read2_b32 v[118:119], v8 offset0:50 offset1:51
    ds_read2_b32 v[120:121], v8 offset0:176 offset1:177
    ds_read2_b32 v[122:123], v8 offset0:178 offset1:179
    buffer_load_dwordx4 a[28:31], v4, s[4:7], s32 offen offset:1024
    ds_read2_b32 v[124:125], v9 offset0:48 offset1:49
    ds_read2_b32 v[126:127], v9 offset0:50 offset1:51
    ds_read2_b32 v[128:129], v9 offset0:176 offset1:177
    ds_read2_b32 v[130:131], v9 offset0:178 offset1:179
    s_waitcnt vmcnt(16)
    v_mul_f32 v216, s28, v216
    s_waitcnt vmcnt(15)
    v_mul_f32 v220, s28, v220
    s_waitcnt vmcnt(14)
    v_mul_f32 v224, s28, v224
    s_waitcnt vmcnt(13)
    v_mul_f32 v228, s28, v228
    v_fma_f32 v217, v217, s28, v254
    v_fma_f32 v221, v221, s28, v254
    v_fma_f32 v225, v225, s28, v254
    v_fma_f32 v229, v229, s28, v254
    v_fma_f32 v217, -v216, v216, v217
    v_fma_f32 v221, -v220, v220, v221
    v_fma_f32 v225, -v224, v224, v225
    v_fma_f32 v229, -v228, v228, v229
    v_max_f32 v217, s29, v217
    v_max_f32 v221, s29, v221
    v_max_f32 v225, s29, v225
    v_max_f32 v229, s29, v229
    v_rsq_f32 v217, v217
    v_rsq_f32 v221, v221
    v_rsq_f32 v225, v225
    v_rsq_f32 v229, v229
    s_waitcnt vmcnt(12)
    v_lshlrev_b32 v232, 16, v212
    v_and_b32 v233, 0xffff0000, v212
    v_lshlrev_b32 v234, 16, v213
    v_and_b32 v235, 0xffff0000, v213
    v_lshlrev_b32 v236, 16, v214
    v_and_b32 v237, 0xffff0000, v214
    v_lshlrev_b32 v238, 16, v215
    v_and_b32 v239, 0xffff0000, v215
    v_subrev_f32_dpp v240, v216, v232 quad_perm:[0,1,0,1] row_mask:0xf bank_mask:0xf
    v_subrev_f32_dpp v241, v220, v233 quad_perm:[0,1,0,1] row_mask:0xf bank_mask:0xf
    v_subrev_f32_dpp v242, v224, v234 quad_perm:[0,1,0,1] row_mask:0xf bank_mask:0xf
    v_subrev_f32_dpp v243, v228, v235 quad_perm:[0,1,0,1] row_mask:0xf bank_mask:0xf
    v_subrev_f32_dpp v244, v216, v236 quad_perm:[2,3,2,3] row_mask:0xf bank_mask:0xf
    v_subrev_f32_dpp v245, v220, v237 quad_perm:[2,3,2,3] row_mask:0xf bank_mask:0xf
    v_subrev_f32_dpp v246, v224, v238 quad_perm:[2,3,2,3] row_mask:0xf bank_mask:0xf
    v_subrev_f32_dpp v247, v228, v239 quad_perm:[2,3,2,3] row_mask:0xf bank_mask:0xf
    v_mul_f32_dpp v240, v217, v240 quad_perm:[0,1,0,1] row_mask:0xf bank_mask:0xf
    v_mul_f32_dpp v241, v221, v241 quad_perm:[0,1,0,1] row_mask:0xf bank_mask:0xf
    v_mul_f32_dpp v242, v225, v242 quad_perm:[0,1,0,1] row_mask:0xf bank_mask:0xf
    v_mul_f32_dpp v243, v229, v243 quad_perm:[0,1,0,1] row_mask:0xf bank_mask:0xf
    v_mul_f32_dpp v244, v217, v244 quad_perm:[2,3,2,3] row_mask:0xf bank_mask:0xf
    v_mul_f32_dpp v245, v221, v245 quad_perm:[2,3,2,3] row_mask:0xf bank_mask:0xf
    v_mul_f32_dpp v246, v225, v246 quad_perm:[2,3,2,3] row_mask:0xf bank_mask:0xf
    v_mul_f32_dpp v247, v229, v247 quad_perm:[2,3,2,3] row_mask:0xf bank_mask:0xf
    v_cvt_pk_bf16_f32 v212, v247, v246
    v_cvt_pk_bf16_f32 v213, v245, v244
    v_cvt_pk_bf16_f32 v214, v243, v242
    v_cvt_pk_bf16_f32 v215, v241, v240
    ds_write_b128 v15, v[212:215] offset:2048
    s_waitcnt lgkmcnt(0)
    s_barrier
    ds_read_b128 v[132:135], v7 offset:3584
    ds_read_b128 v[136:139], v7 offset:3072
    ds_read_b128 v[140:143], v7 offset:2560
    ds_read_b128 v[144:147], v7 offset:2048
    ds_read_b128 v[148:151], v7 offset:3648
    ds_read_b128 v[152:155], v7 offset:3136
    ds_read_b128 v[156:159], v7 offset:2624
    ds_read_b128 v[160:163], v7 offset:2112
    s_mov_b32 s18, 14696448
    s_lshl_b32 s23, s15, 5
    s_add_u32 s23, s23, 1048576
    buffer_load_dwordx4 v[216:219], v6, s[4:7], s18 offen offset:0 sc1
    buffer_load_dwordx4 v[220:223], v6, s[4:7], s18 offen offset:1024 sc1
    buffer_load_dwordx4 v[224:227], v6, s[4:7], s18 offen offset:2048 sc1
    buffer_load_dwordx4 v[228:231], v6, s[4:7], s18 offen offset:3072 sc1
    buffer_load_dwordx4 v[212:215], v248, s[4:7], s23 offen sc1
    s_waitcnt lgkmcnt(7)
    v_mfma_f32_16x16x32_bf16 v[180:183], v[68:71], v[132:135], 0
    s_add_u32 s61, s75, 3145728
    buffer_store_dwordx4 a[252:255], v5, s[4:7], s61 offen sc1
    v_fmac_f32 v232, v66, v240
    v_mfma_f32_16x16x32_bf16 v[184:187], v[72:75], v[132:135], 0
    v_fmac_f32 v233, v66, v241
    s_waitcnt lgkmcnt(6)
    v_mfma_f32_16x16x32_bf16 v[184:187], v[68:71], v[136:139], v[184:187]
    v_fmac_f32 v234, v66, v242
    v_mfma_f32_16x16x32_bf16 v[188:191], v[76:79], v[132:135], 0
    v_fmac_f32 v235, v66, v243
    v_mfma_f32_16x16x32_bf16 v[188:191], v[72:75], v[136:139], v[188:191]
    v_fmac_f32 v236, v66, v244
    s_waitcnt lgkmcnt(5)
    v_mfma_f32_16x16x32_bf16 v[188:191], v[68:71], v[140:143], v[188:191]
    v_fmac_f32 v237, v66, v245
    v_mfma_f32_16x16x32_bf16 v[192:195], v[80:83], v[132:135], 0
    v_fmac_f32 v238, v66, v246
    v_mfma_f32_16x16x32_bf16 v[192:195], v[76:79], v[136:139], v[192:195]
    v_fmac_f32 v239, v66, v247
    v_mfma_f32_16x16x32_bf16 v[192:195], v[72:75], v[140:143], v[192:195]
    s_waitcnt vmcnt(17)
    v_add_f32_dpp v20, v20, v20 quad_perm:[1,0,3,2] row_mask:0xf bank_mask:0xf
    s_waitcnt lgkmcnt(4)
    v_mfma_f32_16x16x32_bf16 v[192:195], v[68:71], v[144:147], v[192:195]
    s_waitcnt lgkmcnt(0)
    v_add_f32_dpp v21, v21, v21 quad_perm:[1,0,3,2] row_mask:0xf bank_mask:0xf
    v_mfma_f32_16x16x32_bf16 v[192:195], v[84:87], v[160:163], v[192:195]
    s_add_u32 s32, s34, 262144
    ds_read_b128 v[132:135], v7 offset:3712
    buffer_load_dwordx4 a[32:35], v4, s[4:7], s32 offen offset:2048
    v_mfma_f32_16x16x32_bf16 v[192:195], v[88:91], v[156:159], v[192:195]
    s_add_u32 s32, s34, 393216
    ds_read_b128 v[136:139], v7 offset:3200
    v_add_f32_dpp v22, v22, v22 quad_perm:[1,0,3,2] row_mask:0xf bank_mask:0xf
    v_mfma_f32_16x16x32_bf16 v[192:195], v[92:95], v[152:155], v[192:195]
    ds_read_b128 v[140:143], v7 offset:2688
    v_add_f32_dpp v23, v23, v23 quad_perm:[1,0,3,2] row_mask:0xf bank_mask:0xf
    v_mfma_f32_16x16x32_bf16 v[192:195], v[96:99], v[148:151], v[192:195]
    ds_read_b128 v[144:147], v7 offset:2176
    s_waitcnt vmcnt(17)
    v_add_f32_dpp v24, v24, v24 quad_perm:[1,0,3,2] row_mask:0xf bank_mask:0xf
    v_mfma_f32_16x16x32_bf16 v[188:191], v[84:87], v[156:159], v[188:191]
    v_add_f32_dpp v25, v25, v25 quad_perm:[1,0,3,2] row_mask:0xf bank_mask:0xf
    v_mfma_f32_16x16x32_bf16 v[188:191], v[88:91], v[152:155], v[188:191]
    buffer_load_dwordx4 a[36:39], v4, s[4:7], s32 offen offset:0
    v_add_f32_dpp v26, v26, v26 quad_perm:[1,0,3,2] row_mask:0xf bank_mask:0xf
    v_mfma_f32_16x16x32_bf16 v[188:191], v[92:95], v[148:151], v[188:191]
    v_add_f32_dpp v27, v27, v27 quad_perm:[1,0,3,2] row_mask:0xf bank_mask:0xf
    v_mfma_f32_16x16x32_bf16 v[184:187], v[84:87], v[152:155], v[184:187]
    v_add_f32_dpp v20, v20, v20 quad_perm:[2,3,0,1] row_mask:0xf bank_mask:0xf
    v_mfma_f32_16x16x32_bf16 v[184:187], v[88:91], v[148:151], v[184:187]
    v_add_f32_dpp v21, v21, v21 quad_perm:[2,3,0,1] row_mask:0xf bank_mask:0xf
    v_mfma_f32_16x16x32_bf16 v[180:183], v[84:87], v[148:151], v[180:183]
    s_waitcnt lgkmcnt(0)
    v_add_f32_dpp v22, v22, v22 quad_perm:[2,3,0,1] row_mask:0xf bank_mask:0xf
    v_mfma_f32_16x16x32_bf16 v[192:195], v[100:103], v[144:147], v[192:195]
    ds_read_b128 v[148:151], v7 offset:3776
    buffer_load_dwordx4 a[40:43], v4, s[4:7], s32 offen offset:1024
    v_mfma_f32_16x16x32_bf16 v[192:195], v[104:107], v[140:143], v[192:195]
    ds_read_b128 v[152:155], v7 offset:3264
    v_add_f32_dpp v23, v23, v23 quad_perm:[2,3,0,1] row_mask:0xf bank_mask:0xf
    v_mfma_f32_16x16x32_bf16 v[192:195], v[108:111], v[136:139], v[192:195]
    ds_read_b128 v[156:159], v7 offset:2752
    v_add_f32_dpp v24, v24, v24 quad_perm:[2,3,0,1] row_mask:0xf bank_mask:0xf
    v_mfma_f32_16x16x32_bf16 v[192:195], v[112:115], v[132:135], v[192:195]
    ds_read_b128 v[160:163], v7 offset:2240
    v_add_f32_dpp v25, v25, v25 quad_perm:[2,3,0,1] row_mask:0xf bank_mask:0xf
    v_mfma_f32_16x16x32_bf16 v[188:191], v[100:103], v[140:143], v[188:191]
    v_add_f32_dpp v26, v26, v26 quad_perm:[2,3,0,1] row_mask:0xf bank_mask:0xf
    v_mfma_f32_16x16x32_bf16 v[188:191], v[104:107], v[136:139], v[188:191]
    buffer_load_dwordx4 a[44:47], v4, s[4:7], s32 offen offset:2048
    s_add_u32 s32, s34, 524288
    v_mfma_f32_16x16x32_bf16 v[188:191], v[108:111], v[132:135], v[188:191]
    v_add_f32_dpp v27, v27, v27 quad_perm:[2,3,0,1] row_mask:0xf bank_mask:0xf
    v_mfma_f32_16x16x32_bf16 v[184:187], v[100:103], v[136:139], v[184:187]
    v_add_f32_dpp v20, v20, v20 row_half_mirror row_mask:0xf bank_mask:0xf
    v_mfma_f32_16x16x32_bf16 v[184:187], v[104:107], v[132:135], v[184:187]
    v_add_f32_dpp v21, v21, v21 row_half_mirror row_mask:0xf bank_mask:0xf
    v_mfma_f32_16x16x32_bf16 v[180:183], v[100:103], v[132:135], v[180:183]
    s_waitcnt lgkmcnt(0)
    v_add_f32_dpp v22, v22, v22 row_half_mirror row_mask:0xf bank_mask:0xf
    v_mfma_f32_16x16x32_bf16 v[180:183], v[116:119], v[148:151], v[180:183]
    ds_read_b128 v[144:147], v7 offset:2048
    buffer_load_dwordx4 a[48:51], v4, s[4:7], s32 offen offset:0
    v_mfma_f32_16x16x32_bf16 v[184:187], v[120:123], v[148:151], v[184:187]
    ds_read_b128 v[140:143], v7 offset:2560
    v_add_f32_dpp v23, v23, v23 row_half_mirror row_mask:0xf bank_mask:0xf
    v_mfma_f32_16x16x32_bf16 v[184:187], v[116:119], v[152:155], v[184:187]
    ds_read_b128 v[136:139], v7 offset:3072
    v_add_f32_dpp v24, v24, v24 row_half_mirror row_mask:0xf bank_mask:0xf
    v_mfma_f32_16x16x32_bf16 v[188:191], v[124:127], v[148:151], v[188:191]
    ds_read_b128 v[132:135], v7 offset:3584
    v_add_f32_dpp v25, v25, v25 row_half_mirror row_mask:0xf bank_mask:0xf
    v_mfma_f32_16x16x32_bf16 v[188:191], v[120:123], v[152:155], v[188:191]
iw1:
    s_cbranch_execz iw5
    ds_write_b128 v12, v[180:183] offset:0
    v_mfma_f32_16x16x32_bf16 v[188:191], v[116:119], v[156:159], v[188:191]
    buffer_load_dwordx4 a[52:55], v4, s[4:7], s32 offen offset:1024
    v_add_f32_dpp v26, v26, v26 row_half_mirror row_mask:0xf bank_mask:0xf
    v_mfma_f32_16x16x32_bf16 v[192:195], v[128:131], v[148:151], v[192:195]
    v_add_f32_dpp v27, v27, v27 row_half_mirror row_mask:0xf bank_mask:0xf
    v_mfma_f32_16x16x32_bf16 v[192:195], v[124:127], v[152:155], v[192:195]
    ds_write_b128 v12, v[184:187] offset:1024
    v_mfma_f32_16x16x32_bf16 v[192:195], v[120:123], v[156:159], v[192:195]
    s_waitcnt vmcnt(20)
    v_add_f32 v28, v28, v29
    v_mfma_f32_16x16x32_bf16 v[192:195], v[116:119], v[160:163], v[192:195]
    ds_write_b128 v12, v[188:191] offset:2048
    v_mov_b32 v29, v28
    s_nop 1
    v_permlane16_swap_b32 v28, v29
    v_add_f32 v28, v28, v29
    v_mov_b32 v29, v28
    s_nop 1
    v_permlane32_swap_b32 v28, v29
    v_add_f32 v28, v28, v29
    v_and_b32 v62, 31, v1
    v_mul_u32_u24 v62, 132, v62
    v_lshrrev_b32 v61, 5, v1
    v_lshl_add_u32 v62, v61, 14, v62
    v_add_u32 v62, s66, v62
    ds_write_b128 v12, v[192:195] offset:3072
    s_add_u32 s22, s75, 2097152
    s_add_u32 s32, s34, 524288
    buffer_load_dwordx4 a[56:59], v4, s[4:7], s32 offen offset:2048
    s_add_u32 s32, s34, 655360
    buffer_load_dwordx4 a[60:63], v4, s[4:7], s32 offen offset:0
    s_waitcnt vmcnt(8)
    s_waitcnt lgkmcnt(0)
    s_barrier
    ds_read_b128 v[164:167], v13 offset:0
    ds_read_b128 v[168:171], v14 offset:0
    ds_read_b128 v[172:175], v13 offset:4096
    ds_read_b128 v[176:179], v14 offset:4096
    s_waitcnt lgkmcnt(3)
    v_add_f32 v232, v232, v164
    v_add_f32 v233, v233, v165
    v_add_f32 v234, v234, v166
    v_add_f32 v235, v235, v167
    s_waitcnt lgkmcnt(2)
    v_add_f32 v236, v236, v168
    v_add_f32 v237, v237, v169
    v_add_f32 v238, v238, v170
    v_add_f32 v239, v239, v171
    s_waitcnt lgkmcnt(1)
    v_add_f32 v232, v232, v172
    v_add_f32 v233, v233, v173
    v_add_f32 v234, v234, v174
    v_add_f32 v235, v235, v175
    s_waitcnt lgkmcnt(0)
    v_add_f32 v236, v236, v176
    v_add_f32 v237, v237, v177
    v_add_f32 v238, v238, v178
    v_add_f32 v239, v239, v179
    v_cvt_pk_bf16_f32 v240, v232, v233
    v_cvt_pk_bf16_f32 v241, v234, v235
    v_cvt_pk_bf16_f32 v242, v236, v237
    v_cvt_pk_bf16_f32 v243, v238, v239
    buffer_store_dwordx4 v[240:243], v5, s[4:7], s22 offen sc1
    ds_read2_b32 v[164:165], v10 offset0:0 offset1:1
    ds_read2_b32 v[166:167], v10 offset0:2 offset1:3
    ds_read2_b32 v[168:169], v10 offset0:128 offset1:129
    ds_read2_b32 v[170:171], v10 offset0:130 offset1:131
    ds_read2_b32 v[172:173], v11 offset0:0 offset1:1
    ds_read2_b32 v[174:175], v11 offset0:2 offset1:3
    ds_read2_b32 v[176:177], v11 offset0:128 offset1:129
    ds_read2_b32 v[178:179], v11 offset0:130 offset1:131
    v_mfma_f32_16x16x32_bf16 v[196:199], v[72:75], v[144:147], 0
    s_add_u32 s32, s34, 655360
    ds_read_b128 v[160:163], v7 offset:2112
    buffer_load_dwordx4 a[64:67], v4, s[4:7], s32 offen offset:1024
    v_mfma_f32_16x16x32_bf16 v[200:203], v[76:79], v[144:147], 0
    ds_read_b128 v[156:159], v7 offset:2624
    v_mul_f32 v216, s28, v216
    v_mfma_f32_16x16x32_bf16 v[196:199], v[76:79], v[140:143], v[196:199]
    ds_read_b128 v[152:155], v7 offset:3136
    v_mul_f32 v220, s28, v220
    v_mfma_f32_16x16x32_bf16 v[204:207], v[80:83], v[144:147], 0
    ds_read_b128 v[148:151], v7 offset:3648
    v_mul_f32 v224, s28, v224
    v_mfma_f32_16x16x32_bf16 v[200:203], v[80:83], v[140:143], v[200:203]
    ds_read2_b32 v[180:181], v10 offset0:16 offset1:17
    v_mul_f32 v228, s28, v228
    v_mfma_f32_16x16x32_bf16 v[196:199], v[80:83], v[136:139], v[196:199]
    ds_read2_b32 v[182:183], v10 offset0:18 offset1:19
    buffer_load_dwordx4 a[68:71], v4, s[4:7], s32 offen offset:2048
    s_waitcnt lgkmcnt(12)
    v_mfma_f32_16x16x32_bf16 v[208:211], v[164:167], v[144:147], 0
    s_add_u32 s32, s34, 786432
    ds_read2_b32 v[184:185], v10 offset0:144 offset1:145
    v_fma_f32 v217, v217, s28, v254
    v_mfma_f32_16x16x32_bf16 v[204:207], v[164:167], v[140:143], v[204:207]
    ds_read2_b32 v[186:187], v10 offset0:146 offset1:147
    v_fma_f32 v221, v221, s28, v254
    v_mfma_f32_16x16x32_bf16 v[200:203], v[164:167], v[136:139], v[200:203]
    ds_read2_b32 v[188:189], v11 offset0:16 offset1:17
    v_fma_f32 v225, v225, s28, v254
    v_mfma_f32_16x16x32_bf16 v[196:199], v[164:167], v[132:135], v[196:199]
    ds_read2_b32 v[190:191], v11 offset0:18 offset1:19
    v_fma_f32 v229, v229, s28, v254
    s_waitcnt lgkmcnt(14)
    v_mfma_f32_16x16x32_bf16 v[208:211], v[168:171], v[140:143], v[208:211]
    ds_read2_b32 v[192:193], v11 offset0:144 offset1:145
    buffer_load_dwordx4 a[72:75], v4, s[4:7], s32 offen offset:0
    v_mfma_f32_16x16x32_bf16 v[204:207], v[168:171], v[136:139], v[204:207]
    ds_read2_b32 v[194:195], v11 offset0:146 offset1:147
    v_fma_f32 v217, -v216, v216, v217
    v_mfma_f32_16x16x32_bf16 v[200:203], v[168:171], v[132:135], v[200:203]
    v_fma_f32 v221, -v220, v220, v221
    v_fma_f32 v225, -v224, v224, v225
    s_waitcnt lgkmcnt(14)
    v_mfma_f32_16x16x32_bf16 v[208:211], v[172:175], v[136:139], v[208:211]
    v_fma_f32 v229, -v228, v228, v229
    v_max_f32 v217, s29, v217
    v_mfma_f32_16x16x32_bf16 v[204:207], v[172:175], v[132:135], v[204:207]
    s_add_u32 s61, s73, 0
    buffer_store_dwordx4 a[252:255], v44, s[4:7], s61 offen sc1
    s_add_u32 s61, s73, 1048576
    s_waitcnt lgkmcnt(12)
    v_mfma_f32_16x16x32_bf16 v[208:211], v[176:179], v[132:135], v[208:211]
    s_waitcnt lgkmcnt(0)
    buffer_load_dwordx4 a[76:79], v4, s[4:7], s32 offen offset:1024
    v_max_f32 v221, s29, v221
    v_mfma_f32_16x16x32_bf16 v[208:211], v[192:195], v[148:151], v[208:211]
    ds_read_b128 v[144:147], v7 offset:2176
    v_max_f32 v225, s29, v225
    v_mfma_f32_16x16x32_bf16 v[208:211], v[188:191], v[152:155], v[208:211]
    ds_read_b128 v[140:143], v7 offset:2688
    v_max_f32 v229, s29, v229
    v_mfma_f32_16x16x32_bf16 v[208:211], v[184:187], v[156:159], v[208:211]
    ds_read_b128 v[136:139], v7 offset:3200
    v_rsq_f32 v217, v217
    v_mfma_f32_16x16x32_bf16 v[208:211], v[180:183], v[160:163], v[208:211]
    ds_read_b128 v[132:135], v7 offset:3712
    v_rsq_f32 v221, v221
    v_mfma_f32_16x16x32_bf16 v[204:207], v[188:191], v[148:151], v[204:207]
    ds_read2_b32 v[164:165], v10 offset0:32 offset1:33
    buffer_load_dwordx4 a[80:83], v4, s[4:7], s32 offen offset:2048
    v_mfma_f32_16x16x32_bf16 v[204:207], v[184:187], v[152:155], v[204:207]
    s_add_u32 s32, s34, 917504
    ds_read2_b32 v[166:167], v10 offset0:34 offset1:35
    v_rsq_f32 v225, v225
    v_mfma_f32_16x16x32_bf16 v[204:207], v[180:183], v[156:159], v[204:207]
    ds_read2_b32 v[168:169], v10 offset0:160 offset1:161
    v_rsq_f32 v229, v229
    v_mfma_f32_16x16x32_bf16 v[204:207], v[96:99], v[160:163], v[204:207]
    ds_read2_b32 v[170:171], v10 offset0:162 offset1:163
    v_lshlrev_b32 v232, 16, v212
    v_mfma_f32_16x16x32_bf16 v[200:203], v[184:187], v[148:151], v[200:203]
    ds_read2_b32 v[172:173], v11 offset0:32 offset1:33
    v_and_b32 v233, 0xffff0000, v212
    v_mfma_f32_16x16x32_bf16 v[200:203], v[180:183], v[152:155], v[200:203]
    ds_read2_b32 v[174:175], v11 offset0:34 offset1:35
    buffer_load_dwordx4 a[84:87], v4, s[4:7], s32 offen offset:0
    v_mfma_f32_16x16x32_bf16 v[200:203], v[96:99], v[156:159], v[200:203]
    ds_read2_b32 v[176:177], v11 offset0:160 offset1:161
    buffer_store_dwordx4 a[252:255], v44, s[4:7], s61 offen sc1
    v_mfma_f32_16x16x32_bf16 v[200:203], v[92:95], v[160:163], v[200:203]
    s_mov_b32 s61, 4194304
    ds_read2_b32 v[178:179], v11 offset0:162 offset1:163
    v_lshlrev_b32 v234, 16, v213
    v_mfma_f32_16x16x32_bf16 v[196:199], v[180:183], v[148:151], v[196:199]
    v_and_b32 v235, 0xffff0000, v213
    v_lshlrev_b32 v236, 16, v214
    v_mfma_f32_16x16x32_bf16 v[196:199], v[96:99], v[152:155], v[196:199]
    v_and_b32 v237, 0xffff0000, v214
    v_lshlrev_b32 v238, 16, v215
    v_mfma_f32_16x16x32_bf16 v[196:199], v[92:95], v[156:159], v[196:199]
    buffer_load_dwordx4 a[88:91], v4, s[4:7], s32 offen offset:1024
    v_and_b32 v239, 0xffff0000, v215
    v_mfma_f32_16x16x32_bf16 v[196:199], v[88:91], v[160:163], v[196:199]
    s_waitcnt lgkmcnt(0)
    v_subrev_f32_dpp v240, v216, v232 quad_perm:[0,1,0,1] row_mask:0xf bank_mask:0xf
    v_subrev_f32_dpp v241, v220, v233 quad_perm:[0,1,0,1] row_mask:0xf bank_mask:0xf
    v_mfma_f32_16x16x32_bf16 v[196:199], v[104:107], v[144:147], v[196:199]
    ds_read_b128 v[160:163], v7 offset:2240
    v_subrev_f32_dpp v242, v224, v234 quad_perm:[0,1,0,1] row_mask:0xf bank_mask:0xf
    v_mfma_f32_16x16x32_bf16 v[196:199], v[108:111], v[140:143], v[196:199]
    ds_read_b128 v[156:159], v7 offset:2752
    v_subrev_f32_dpp v243, v228, v235 quad_perm:[0,1,0,1] row_mask:0xf bank_mask:0xf
    v_mfma_f32_16x16x32_bf16 v[196:199], v[112:115], v[136:139], v[196:199]
    ds_read_b128 v[152:155], v7 offset:3264
    v_subrev_f32_dpp v244, v216, v236 quad_perm:[2,3,2,3] row_mask:0xf bank_mask:0xf
    v_mfma_f32_16x16x32_bf16 v[196:199], v[164:167], v[132:135], v[196:199]
    ds_read_b128 v[148:151], v7 offset:3776
    buffer_load_dwordx4 a[92:95], v4, s[4:7], s32 offen offset:2048
    v_mfma_f32_16x16x32_bf16 v[200:203], v[108:111], v[144:147], v[200:203]
    s_add_u32 s32, s34, 1048576
    ds_read2_b32 v[180:181], v10 offset0:48 offset1:49
    v_subrev_f32_dpp v245, v220, v237 quad_perm:[2,3,2,3] row_mask:0xf bank_mask:0xf
    v_mfma_f32_16x16x32_bf16 v[200:203], v[112:115], v[140:143], v[200:203]
    ds_read2_b32 v[182:183], v10 offset0:50 offset1:51
    v_subrev_f32_dpp v246, v224, v238 quad_perm:[2,3,2,3] row_mask:0xf bank_mask:0xf
    v_mfma_f32_16x16x32_bf16 v[200:203], v[164:167], v[136:139], v[200:203]
    ds_read2_b32 v[184:185], v10 offset0:176 offset1:177
    buffer_store_dwordx4 a[252:255], v50, s[4:7], s61 offen sc1
    v_mfma_f32_16x16x32_bf16 v[200:203], v[168:171], v[132:135], v[200:203]
    s_mov_b32 s61, 5242880
    ds_read2_b32 v[186:187], v10 offset0:178 offset1:179
    v_subrev_f32_dpp v247, v228, v239 quad_perm:[2,3,2,3] row_mask:0xf bank_mask:0xf
    v_mfma_f32_16x16x32_bf16 v[204:207], v[112:115], v[144:147], v[204:207]
    ds_read2_b32 v[188:189], v11 offset0:48 offset1:49
    buffer_load_dwordx4 a[96:99], v4, s[4:7], s32 offen offset:0
    v_mfma_f32_16x16x32_bf16 v[204:207], v[164:167], v[140:143], v[204:207]
    ds_read2_b32 v[190:191], v11 offset0:50 offset1:51
    v_mul_f32_dpp v240, v217, v240 quad_perm:[0,1,0,1] row_mask:0xf bank_mask:0xf
    v_mfma_f32_16x16x32_bf16 v[204:207], v[168:171], v[136:139], v[204:207]
    ds_read2_b32 v[192:193], v11 offset0:176 offset1:177
    v_mul_f32_dpp v241, v221, v241 quad_perm:[0,1,0,1] row_mask:0xf bank_mask:0xf
    v_mfma_f32_16x16x32_bf16 v[204:207], v[172:175], v[132:135], v[204:207]
    ds_read2_b32 v[194:195], v11 offset0:178 offset1:179
    v_mul_f32_dpp v242, v225, v242 quad_perm:[0,1,0,1] row_mask:0xf bank_mask:0xf
    v_mfma_f32_16x16x32_bf16 v[208:211], v[164:167], v[144:147], v[208:211]
    v_mul_f32_dpp v243, v229, v243 quad_perm:[0,1,0,1] row_mask:0xf bank_mask:0xf
    v_mul_f32_dpp v244, v217, v244 quad_perm:[2,3,2,3] row_mask:0xf bank_mask:0xf
    v_mfma_f32_16x16x32_bf16 v[208:211], v[168:171], v[140:143], v[208:211]
    buffer_load_dwordx4 a[100:103], v4, s[4:7], s32 offen offset:1024
    v_mul_f32_dpp v245, v221, v245 quad_perm:[2,3,2,3] row_mask:0xf bank_mask:0xf
    v_mfma_f32_16x16x32_bf16 v[208:211], v[172:175], v[136:139], v[208:211]
    v_mul_f32_dpp v246, v225, v246 quad_perm:[2,3,2,3] row_mask:0xf bank_mask:0xf
    v_mul_f32_dpp v247, v229, v247 quad_perm:[2,3,2,3] row_mask:0xf bank_mask:0xf
    v_mfma_f32_16x16x32_bf16 v[208:211], v[176:179], v[132:135], v[208:211]
    s_waitcnt lgkmcnt(0)
    v_cvt_pk_bf16_f32 v212, v247, v246
    v_cvt_pk_bf16_f32 v213, v245, v244
    v_mfma_f32_16x16x32_bf16 v[208:211], v[192:195], v[148:151], v[208:211]
    v_cvt_pk_bf16_f32 v214, v243, v242
    v_cvt_pk_bf16_f32 v215, v241, v240
    v_mfma_f32_16x16x32_bf16 v[208:211], v[188:191], v[152:155], v[208:211]
    ds_write_b128 v15, v[212:215] offset:0
    v_mfma_f32_16x16x32_bf16 v[208:211], v[184:187], v[156:159], v[208:211]
    buffer_store_dwordx4 a[252:255], v50, s[4:7], s61 offen sc1
    buffer_load_dwordx4 a[104:107], v4, s[4:7], s32 offen offset:2048
    v_mfma_f32_16x16x32_bf16 v[208:211], v[180:183], v[160:163], v[208:211]
    s_add_u32 s32, s34, 1179648
    v_mfma_f32_16x16x32_bf16 v[204:207], v[188:191], v[148:151], v[204:207]
    v_mfma_f32_16x16x32_bf16 v[204:207], v[184:187], v[152:155], v[204:207]
    s_waitcnt lgkmcnt(0)
    v_mfma_f32_16x16x32_bf16 v[204:207], v[180:183], v[156:159], v[204:207]
    s_barrier
    ds_read_b128 v[132:135], v7 offset:1536
    v_mfma_f32_16x16x32_bf16 v[204:207], v[128:131], v[160:163], v[204:207]
    buffer_load_dwordx4 a[108:111], v4, s[4:7], s32 offen offset:0
    ds_read_b128 v[136:139], v7 offset:1024
    v_mfma_f32_16x16x32_bf16 v[200:203], v[184:187], v[148:151], v[200:203]
    ds_read_b128 v[140:143], v7 offset:512
    v_mfma_f32_16x16x32_bf16 v[200:203], v[180:183], v[152:155], v[200:203]
    ds_read_b128 v[144:147], v7 offset:0
    v_mfma_f32_16x16x32_bf16 v[200:203], v[128:131], v[156:159], v[200:203]
    v_mfma_f32_16x16x32_bf16 v[200:203], v[124:127], v[160:163], v[200:203]
    v_mfma_f32_16x16x32_bf16 v[196:199], v[180:183], v[148:151], v[196:199]
    v_mfma_f32_16x16x32_bf16 v[196:199], v[128:131], v[152:155], v[196:199]
    v_mfma_f32_16x16x32_bf16 v[196:199], v[124:127], v[156:159], v[196:199]
    v_mfma_f32_16x16x32_bf16 v[196:199], v[120:123], v[160:163], v[196:199]
    s_waitcnt lgkmcnt(3)
    v_mfma_f32_16x16x32_bf16 v[196:199], v[68:71], v[132:135], v[196:199]
    ds_read_b128 v[148:151], v7 offset:1600
    v_fmac_f32 v232, v66, v240
    v_mfma_f32_16x16x32_bf16 v[200:203], v[72:75], v[132:135], v[200:203]
    ds_read_b128 v[152:155], v7 offset:1088
    v_fmac_f32 v233, v66, v241
    s_waitcnt lgkmcnt(4)
    v_mfma_f32_16x16x32_bf16 v[200:203], v[68:71], v[136:139], v[200:203]
    ds_read_b128 v[156:159], v7 offset:576
    v_fmac_f32 v234, v66, v242
    v_mfma_f32_16x16x32_bf16 v[204:207], v[76:79], v[132:135], v[204:207]
    ds_read_b128 v[160:163], v7 offset:64
    v_fmac_f32 v235, v66, v243
    v_mfma_f32_16x16x32_bf16 v[204:207], v[72:75], v[136:139], v[204:207]
    v_fmac_f32 v236, v66, v244
    s_waitcnt lgkmcnt(5)
    v_mfma_f32_16x16x32_bf16 v[204:207], v[68:71], v[140:143], v[204:207]
    v_fmac_f32 v237, v66, v245
    v_mfma_f32_16x16x32_bf16 v[208:211], v[80:83], v[132:135], v[208:211]
    v_fmac_f32 v238, v66, v246
    v_mfma_f32_16x16x32_bf16 v[208:211], v[76:79], v[136:139], v[208:211]
    v_fmac_f32 v239, v66, v247
    v_mfma_f32_16x16x32_bf16 v[208:211], v[72:75], v[140:143], v[208:211]
    s_waitcnt lgkmcnt(4)
    v_mfma_f32_16x16x32_bf16 v[208:211], v[68:71], v[144:147], v[208:211]
    s_waitcnt lgkmcnt(0)
    v_mfma_f32_16x16x32_bf16 v[208:211], v[84:87], v[160:163], v[208:211]
    ds_read_b128 v[132:135], v7 offset:1664
    v_mfma_f32_16x16x32_bf16 v[208:211], v[88:91], v[156:159], v[208:211]
    ds_read_b128 v[136:139], v7 offset:1152
    v_mfma_f32_16x16x32_bf16 v[208:211], v[92:95], v[152:155], v[208:211]
    s_add_u32 s36, s64, 0
    s_add_u32 s38, s36, 16384
    ds_read_b128 v[140:143], v7 offset:640
    v_mfma_f32_16x16x32_bf16 v[208:211], v[96:99], v[148:151], v[208:211]
    s_sub_u32 s37, s36, s65
    s_add_u32 m0, s66, 65536
    ds_read_b128 v[144:147], v7 offset:128
    v_mfma_f32_16x16x32_bf16 v[204:207], v[84:87], v[156:159], v[204:207]
    buffer_load_dwordx4 v4, s[4:7], s37 offen offset:0 sc1 lds
    s_add_u32 m0, s66, 0
    v_mfma_f32_16x16x32_bf16 v[204:207], v[88:91], v[152:155], v[204:207]
    v_mfma_f32_16x16x32_bf16 v[204:207], v[92:95], v[148:151], v[204:207]
    v_mfma_f32_16x16x32_bf16 v[200:203], v[84:87], v[152:155], v[200:203]
    buffer_load_dwordx4 v4, s[4:7], s36 offen offset:0 sc1 lds
    s_add_u32 m0, s66, 16384
    v_mfma_f32_16x16x32_bf16 v[200:203], v[88:91], v[148:151], v[200:203]
    v_mfma_f32_16x16x32_bf16 v[196:199], v[84:87], v[148:151], v[196:199]
    s_waitcnt lgkmcnt(0)
    v_mfma_f32_16x16x32_bf16 v[208:211], v[100:103], v[144:147], v[208:211]
    ds_read_b128 v[148:151], v7 offset:1728
    buffer_load_dwordx4 v4, s[4:7], s38 offen offset:0 sc1 lds
    v_mfma_f32_16x16x32_bf16 v[208:211], v[104:107], v[140:143], v[208:211]
    s_add_u32 m0, s66, 65536
    ds_read_b128 v[152:155], v7 offset:1216
    v_mfma_f32_16x16x32_bf16 v[208:211], v[108:111], v[136:139], v[208:211]
    ds_read_b128 v[156:159], v7 offset:704
    v_mfma_f32_16x16x32_bf16 v[208:211], v[112:115], v[132:135], v[208:211]
    ds_read_b128 v[160:163], v7 offset:192
    buffer_load_dwordx4 v4, s[4:7], s37 offen offset:1024 sc1 lds
    v_mfma_f32_16x16x32_bf16 v[204:207], v[100:103], v[140:143], v[204:207]
    s_add_u32 m0, s66, 0
    v_mfma_f32_16x16x32_bf16 v[204:207], v[104:107], v[136:139], v[204:207]
    v_mfma_f32_16x16x32_bf16 v[204:207], v[108:111], v[132:135], v[204:207]
    buffer_load_dwordx4 v4, s[4:7], s36 offen offset:1024 sc1 lds
    s_add_u32 m0, s66, 16384
    v_mfma_f32_16x16x32_bf16 v[200:203], v[100:103], v[136:139], v[200:203]
    v_mfma_f32_16x16x32_bf16 v[200:203], v[104:107], v[132:135], v[200:203]
    v_mfma_f32_16x16x32_bf16 v[196:199], v[100:103], v[132:135], v[196:199]
    s_waitcnt lgkmcnt(0)
    buffer_load_dwordx4 v4, s[4:7], s38 offen offset:1024 sc1 lds
    s_add_u32 m0, s66, 65536
    v_mfma_f32_16x16x32_bf16 v[196:199], v[116:119], v[148:151], v[196:199]
    v_mfma_f32_16x16x32_bf16 v[200:203], v[120:123], v[148:151], v[200:203]
    v_mfma_f32_16x16x32_bf16 v[200:203], v[116:119], v[152:155], v[200:203]
    buffer_load_dwordx4 v4, s[4:7], s37 offen offset:2048 sc1 lds
    s_add_u32 m0, s66, 0
    v_mfma_f32_16x16x32_bf16 v[204:207], v[124:127], v[148:151], v[204:207]
    v_mfma_f32_16x16x32_bf16 v[204:207], v[120:123], v[152:155], v[204:207]
    s_nop 1
    ds_write_b128 v12, v[196:199] offset:0
    v_mfma_f32_16x16x32_bf16 v[204:207], v[116:119], v[156:159], v[204:207]
    buffer_load_dwordx4 v4, s[4:7], s36 offen offset:2048 sc1 lds
    s_add_u32 m0, s66, 16384
    v_mfma_f32_16x16x32_bf16 v[208:211], v[128:131], v[148:151], v[208:211]
    v_mfma_f32_16x16x32_bf16 v[208:211], v[124:127], v[152:155], v[208:211]
    ds_write_b128 v12, v[200:203] offset:1024
    v_mfma_f32_16x16x32_bf16 v[208:211], v[120:123], v[156:159], v[208:211]
    buffer_load_dwordx4 v4, s[4:7], s38 offen offset:2048 sc1 lds
    s_add_u32 m0, s66, 65536
    v_mfma_f32_16x16x32_bf16 v[208:211], v[116:119], v[160:163], v[208:211]
    ds_write_b128 v12, v[204:207] offset:2048
    s_nop 6
    ds_write_b128 v12, v[208:211] offset:3072
    s_add_u32 s22, s75, 3145728
    buffer_load_dwordx4 v4, s[4:7], s37 offen offset:3072 sc1 lds
    s_add_u32 m0, s66, 0
    s_nop 0
    buffer_load_dwordx4 v4, s[4:7], s36 offen offset:3072 sc1 lds
    s_waitcnt vmcnt(13)
    s_waitcnt lgkmcnt(0)
    s_barrier
    ds_read_b128 v[164:167], v13 offset:0
    ds_read_b128 v[168:171], v14 offset:0
    ds_read_b128 v[172:175], v13 offset:4096
    ds_read_b128 v[176:179], v14 offset:4096
    s_add_u32 m0, s66, 16384
    s_nop 0
    buffer_load_dwordx4 v4, s[4:7], s38 offen offset:3072 sc1 lds
    s_waitcnt lgkmcnt(3)
    v_add_f32 v232, v232, v164
    v_add_f32 v233, v233, v165
    v_add_f32 v234, v234, v166
    v_add_f32 v235, v235, v167
    s_waitcnt lgkmcnt(2)
    v_add_f32 v236, v236, v168
    v_add_f32 v237, v237, v169
    v_add_f32 v238, v238, v170
    v_add_f32 v239, v239, v171
    s_waitcnt lgkmcnt(1)
    v_add_f32 v232, v232, v172
    v_add_f32 v233, v233, v173
    v_add_f32 v234, v234, v174
    v_add_f32 v235, v235, v175
    s_waitcnt lgkmcnt(0)
    v_add_f32 v236, v236, v176
    v_add_f32 v237, v237, v177
    v_add_f32 v238, v238, v178
    v_add_f32 v239, v239, v179
    v_cvt_pk_bf16_f32 v240, v232, v233
    v_cvt_pk_bf16_f32 v241, v234, v235
    v_cvt_pk_bf16_f32 v242, v236, v237
    v_cvt_pk_bf16_f32 v243, v238, v239
    buffer_store_dwordx4 v[240:243], v5, s[4:7], s22 offen sc1
    s_waitcnt vmcnt(7)
    ds_read_b64_tr_b16 v[124:125], v43 offset:0
    ds_read_b64_tr_b16 v[126:127], v43 offset:512
    ds_read_b64_tr_b16 v[128:129], v42 offset:0
    ds_read_b64_tr_b16 v[130:131], v42 offset:512
    ds_read_b64_tr_b16 v[132:133], v42 offset:16384
    ds_read_b64_tr_b16 v[134:135], v42 offset:16896
    ds_read_b64_tr_b16 v[136:137], v43 offset:1024
    ds_read_b64_tr_b16 v[138:139], v43 offset:1536
    ds_read_b64_tr_b16 v[140:141], v42 offset:1024
    ds_read_b64_tr_b16 v[142:143], v42 offset:1536
    ds_read_b64_tr_b16 v[144:145], v42 offset:17408
    ds_read_b64_tr_b16 v[146:147], v42 offset:17920
    s_waitcnt lgkmcnt(10)
    v_mfma_f32_16x16x32_bf16 v[112:115], v[16:19], v[124:127], 0
    s_waitcnt vmcnt(1)
    ds_read_b64_tr_b16 v[148:149], v43 offset:2048
    ds_read_b64_tr_b16 v[150:151], v43 offset:2560
    s_waitcnt lgkmcnt(10)
    v_mfma_f32_16x16x32_bf16 v[116:119], v[16:19], v[128:131], 0
    s_add_u32 s32, s34, 1179648
    ds_read_b64_tr_b16 v[152:153], v42 offset:2048
    ds_read_b64_tr_b16 v[154:155], v42 offset:2560
    s_waitcnt lgkmcnt(10)
    v_mfma_f32_16x16x32_bf16 v[120:123], v[16:19], v[132:135], 0
    ds_read_b64_tr_b16 v[156:157], v42 offset:18432
    ds_read_b64_tr_b16 v[158:159], v42 offset:18944
    v_mfma_f32_16x16x32_bf16 v[100:103], v[124:127], v[124:127], 0
    ds_read_b64_tr_b16 v[178:179], v43 offset:3072
    ds_read_b64_tr_b16 v[180:181], v43 offset:3584
    v_mfma_f32_16x16x32_bf16 v[104:107], v[128:131], v[128:131], 0
    ds_read_b64_tr_b16 v[182:183], v42 offset:3072
    ds_read_b64_tr_b16 v[184:185], v42 offset:3584
    v_mfma_f32_16x16x32_bf16 v[108:111], v[132:135], v[132:135], 0
    s_waitcnt lgkmcnt(10)
    ds_read_b64_tr_b16 v[186:187], v42 offset:19456
    ds_read_b64_tr_b16 v[188:189], v42 offset:19968
    v_mfma_f32_16x16x32_bf16 v[112:115], v[16:19], v[136:139], v[112:115]
    buffer_load_dwordx4 a[112:115], v4, s[4:7], s32 offen offset:1024
    v_mfma_f32_16x16x32_bf16 v[116:119], v[16:19], v[140:143], v[116:119]
    v_mfma_f32_16x16x32_bf16 v[120:123], v[16:19], v[144:147], v[120:123]
    s_waitcnt lgkmcnt(6)
    v_mfma_f32_16x16x32_bf16 v[112:115], v[16:19], v[148:151], v[112:115]
    v_mfma_f32_16x16x32_bf16 v[116:119], v[16:19], v[152:155], v[116:119]
    buffer_load_dwordx4 a[116:119], v4, s[4:7], s32 offen offset:2048
    s_add_u32 s32, s34, 1310720
    v_mfma_f32_16x16x32_bf16 v[120:123], v[16:19], v[156:159], v[120:123]
    s_waitcnt lgkmcnt(0)
    v_mfma_f32_16x16x32_bf16 v[112:115], v[16:19], v[178:181], v[112:115]
    v_mfma_f32_16x16x32_bf16 v[116:119], v[16:19], v[182:185], v[116:119]
    v_mfma_f32_16x16x32_bf16 v[120:123], v[16:19], v[186:189], v[120:123]
    buffer_load_dwordx4 a[120:123], v4, s[4:7], s32 offen offset:0
    v_mfma_f32_16x16x32_bf16 v[100:103], v[136:139], v[136:139], v[100:103]
    v_mfma_f32_16x16x32_bf16 v[104:107], v[140:143], v[140:143], v[104:107]
    v_mfma_f32_16x16x32_bf16 v[108:111], v[144:147], v[144:147], v[108:111]
    s_nop 2
    v_add_f32 v252, v112, v116
    v_cmp_u_f32 vcc, v252, v120
    v_mfma_f32_16x16x32_bf16 v[100:103], v[148:151], v[148:151], v[100:103]
    buffer_load_dwordx4 a[124:127], v4, s[4:7], s32 offen offset:1024
    s_cbranch_vccnz sr00
so00:
    v_mfma_f32_16x16x32_bf16 v[104:107], v[152:155], v[152:155], v[104:107]
    s_barrier
    ds_read_b64_tr_b16 v[124:125], v41 offset:0
    ds_read_b64_tr_b16 v[126:127], v41 offset:512
    v_mfma_f32_16x16x32_bf16 v[108:111], v[156:159], v[156:159], v[108:111]
    ds_read_b64_tr_b16 v[128:129], v40 offset:0
    ds_read_b64_tr_b16 v[130:131], v40 offset:512
    v_mfma_f32_16x16x32_bf16 v[100:103], v[178:181], v[178:181], v[100:103]
    ds_read_b64_tr_b16 v[132:133], v40 offset:16384
    ds_read_b64_tr_b16 v[134:135], v40 offset:16896
    v_mfma_f32_16x16x32_bf16 v[104:107], v[182:185], v[182:185], v[104:107]
    ds_read_b64_tr_b16 v[136:137], v41 offset:1024
    ds_read_b64_tr_b16 v[138:139], v41 offset:1536
    v_mfma_f32_16x16x32_bf16 v[108:111], v[186:189], v[186:189], v[108:111]
    ds_read_b64_tr_b16 v[140:141], v40 offset:1024
    ds_read_b64_tr_b16 v[142:143], v40 offset:1536
    ds_read_b64_tr_b16 v[144:145], v40 offset:17408
    ds_read_b64_tr_b16 v[146:147], v40 offset:17920
    buffer_load_dwordx4 a[128:131], v4, s[4:7], s32 offen offset:2048
    s_waitcnt lgkmcnt(10)
    v_mfma_f32_16x16x32_bf16 v[76:79], a[4:7], v[124:127], 0
    s_add_u32 s32, s34, 1441792
    ds_read_b64_tr_b16 v[148:149], v41 offset:2048
    buffer_load_dwordx4 a[132:135], v4, s[4:7], s32 offen offset:0
    v_mfma_f32_16x16x32_bf16 v[88:91], v[124:127], a[8:11], 0
    ds_read_b64_tr_b16 v[150:151], v41 offset:2560
    v_cndmask_b32 v113, v100, v101, s[48:49]
    s_waitcnt lgkmcnt(10)
    v_mfma_f32_16x16x32_bf16 v[68:71], a[0:3], v[128:131], 0
    ds_read_b64_tr_b16 v[152:153], v40 offset:2048
    v_cndmask_b32 v113, v113, v102, s[50:51]
    v_mfma_f32_16x16x32_bf16 v[80:83], a[4:7], v[128:131], 0
    ds_read_b64_tr_b16 v[154:155], v40 offset:2560
    v_cndmask_b32 v113, v113, v103, s[52:53]
    v_mfma_f32_16x16x32_bf16 v[92:95], v[128:131], a[8:11], 0
    ds_read_b64_tr_b16 v[156:157], v40 offset:18432
    v_cndmask_b32 v117, v104, v105, s[48:49]
    s_waitcnt lgkmcnt(11)
    v_mfma_f32_16x16x32_bf16 v[72:75], a[0:3], v[132:135], 0
    ds_read_b64_tr_b16 v[158:159], v40 offset:18944
    v_cndmask_b32 v117, v117, v106, s[50:51]
    v_mfma_f32_16x16x32_bf16 v[84:87], a[4:7], v[132:135], 0
    ds_read_b64_tr_b16 v[124:125], v41 offset:3072
    v_cndmask_b32 v117, v117, v107, s[52:53]
    v_mfma_f32_16x16x32_bf16 v[96:99], v[132:135], a[8:11], 0
    s_waitcnt lgkmcnt(7)
    ds_read_b64_tr_b16 v[126:127], v41 offset:3584
    v_cndmask_b32 v121, v108, v109, s[48:49]
    v_mfma_f32_16x16x32_bf16 v[76:79], a[16:19], v[136:139], v[76:79]
    ds_read_b64_tr_b16 v[128:129], v40 offset:3072
    v_cndmask_b32 v121, v121, v110, s[50:51]
    v_mfma_f32_16x16x32_bf16 v[88:91], v[136:139], a[20:23], v[88:91]
    ds_read_b64_tr_b16 v[130:131], v40 offset:3584
    v_cndmask_b32 v121, v121, v111, s[52:53]
    v_mfma_f32_16x16x32_bf16 v[68:71], a[12:15], v[140:143], v[68:71]
    ds_write_b64 v52, v[112:113] offset:0
    buffer_load_dwordx4 a[136:139], v4, s[4:7], s32 offen offset:1024
    v_mfma_f32_16x16x32_bf16 v[80:83], a[16:19], v[140:143], v[80:83]
    ds_read_b64_tr_b16 v[132:133], v40 offset:19456
    ds_write_b64 v52, v[116:117] offset:128
    v_mfma_f32_16x16x32_bf16 v[92:95], v[140:143], a[20:23], v[92:95]
    ds_read_b64_tr_b16 v[134:135], v40 offset:19968
    ds_write_b64 v52, v[120:121] offset:256
    v_mfma_f32_16x16x32_bf16 v[72:75], a[12:15], v[144:147], v[72:75]
    v_mfma_f32_16x16x32_bf16 v[84:87], a[16:19], v[144:147], v[84:87]
    ds_read_b64_tr_b16 v[136:137], v41 offset:4096
    buffer_load_dwordx4 a[140:143], v4, s[4:7], s32 offen offset:2048
    v_mfma_f32_16x16x32_bf16 v[96:99], v[144:147], a[20:23], v[96:99]
    s_waitcnt lgkmcnt(10)
    s_add_u32 s32, s34, 1572864
    ds_read_b64_tr_b16 v[138:139], v41 offset:4608
    v_mfma_f32_16x16x32_bf16 v[76:79], a[28:31], v[148:151], v[76:79]
    ds_read_b64_tr_b16 v[140:141], v40 offset:4096
    v_mfma_f32_16x16x32_bf16 v[88:91], v[148:151], a[32:35], v[88:91]
    ds_read_b64_tr_b16 v[142:143], v40 offset:4608
    v_mfma_f32_16x16x32_bf16 v[68:71], a[24:27], v[152:155], v[68:71]
    s_waitcnt lgkmcnt(4)
    s_barrier
    ds_read_b64 v[160:161], v53 offset:0
    v_mfma_f32_16x16x32_bf16 v[80:83], a[28:31], v[152:155], v[80:83]
    ds_read_b64_tr_b16 v[144:145], v40 offset:20480
    ds_read_b64 v[162:163], v53 offset:512
    v_mfma_f32_16x16x32_bf16 v[92:95], v[152:155], a[32:35], v[92:95]
    ds_read_b64_tr_b16 v[146:147], v40 offset:20992
    ds_read_b64 v[164:165], v53 offset:1024
    v_mfma_f32_16x16x32_bf16 v[72:75], a[24:27], v[156:159], v[72:75]
    ds_read_b64 v[166:167], v53 offset:1536
    buffer_load_dwordx4 a[144:147], v4, s[4:7], s32 offen offset:0
    v_mfma_f32_16x16x32_bf16 v[84:87], a[28:31], v[156:159], v[84:87]
    ds_read_b64_tr_b16 v[148:149], v41 offset:5120
    v_mfma_f32_16x16x32_bf16 v[96:99], v[156:159], a[32:35], v[96:99]
    ds_read_b64_tr_b16 v[150:151], v41 offset:5632
    v_mfma_f32_16x16x32_bf16 v[76:79], a[40:43], v[124:127], v[76:79]
    ds_read_b64_tr_b16 v[152:153], v40 offset:5120
    v_mfma_f32_16x16x32_bf16 v[88:91], v[124:127], a[44:47], v[88:91]
    ds_read_b64_tr_b16 v[154:155], v40 offset:5632
    buffer_load_dwordx4 a[148:151], v4, s[4:7], s32 offen offset:1024
    v_mfma_f32_16x16x32_bf16 v[68:71], a[36:39], v[128:131], v[68:71]
    v_mfma_f32_16x16x32_bf16 v[80:83], a[40:43], v[128:131], v[80:83]
    ds_read_b64_tr_b16 v[156:157], v40 offset:21504
    v_mfma_f32_16x16x32_bf16 v[92:95], v[128:131], a[44:47], v[92:95]
    s_waitcnt lgkmcnt(5)
    ds_read_b64_tr_b16 v[158:159], v40 offset:22016
    v_add_f32 v160, v160, v162
    v_mfma_f32_16x16x32_bf16 v[72:75], a[36:39], v[132:135], v[72:75]
    buffer_load_dwordx4 a[152:155], v4, s[4:7], s32 offen offset:2048
    v_add_f32 v161, v161, v163
    v_mfma_f32_16x16x32_bf16 v[84:87], a[40:43], v[132:135], v[84:87]
    s_add_u32 s32, s34, 1703936
    ds_read_b64_tr_b16 v[124:125], v41 offset:6144
    v_add_f32 v164, v164, v166
    v_mfma_f32_16x16x32_bf16 v[96:99], v[132:135], a[44:47], v[96:99]
    ds_read_b64_tr_b16 v[126:127], v41 offset:6656
    v_add_f32 v165, v165, v167
    v_mfma_f32_16x16x32_bf16 v[76:79], a[52:55], v[136:139], v[76:79]
    ds_read_b64_tr_b16 v[128:129], v40 offset:6144
    v_add_f32 v160, v160, v164
    v_mfma_f32_16x16x32_bf16 v[88:91], v[136:139], a[56:59], v[88:91]
    ds_read_b64_tr_b16 v[130:131], v40 offset:6656
    v_add_f32 v161, v161, v165
    v_mfma_f32_16x16x32_bf16 v[68:71], a[48:51], v[140:143], v[68:71]
    buffer_load_dwordx4 a[156:159], v4, s[4:7], s32 offen offset:0
    v_mul_f32 v170, s28, v160
    v_mfma_f32_16x16x32_bf16 v[80:83], a[52:55], v[140:143], v[80:83]
    ds_read_b64_tr_b16 v[132:133], v40 offset:22528
    v_mul_f32 v161, s28, v161
    v_mfma_f32_16x16x32_bf16 v[92:95], v[140:143], a[56:59], v[92:95]
iw2:
    s_cbranch_execz iw6
    ds_read_b64_tr_b16 v[134:135], v40 offset:23040
    v_fma_f32 v161, -v170, v170, v161
    v_mfma_f32_16x16x32_bf16 v[72:75], a[48:51], v[144:147], v[72:75]
    v_max_f32 v161, 0, v161
    v_mfma_f32_16x16x32_bf16 v[84:87], a[52:55], v[144:147], v[84:87]
    ds_read_b64_tr_b16 v[136:137], v41 offset:7168
    v_add_f32 v161, s29, v161
    v_mfma_f32_16x16x32_bf16 v[96:99], v[144:147], a[56:59], v[96:99]
    s_waitcnt lgkmcnt(7)
    ds_read_b64_tr_b16 v[138:139], v41 offset:7680
    v_sqrt_f32 v161, v161
    v_mfma_f32_16x16x32_bf16 v[76:79], a[64:67], v[148:151], v[76:79]
    ds_read_b64_tr_b16 v[140:141], v40 offset:7168
    v_cvt_pk_bf16_f32 v162, v161, v161
    v_mfma_f32_16x16x32_bf16 v[88:91], v[148:151], a[68:71], v[88:91]
    ds_read_b64_tr_b16 v[142:143], v40 offset:7680
    v_and_b32 v161, 0xffff0000, v162
    v_mfma_f32_16x16x32_bf16 v[68:71], a[60:63], v[152:155], v[68:71]
    buffer_load_dwordx4 a[160:163], v4, s[4:7], s32 offen offset:1024
    v_rcp_f32 v168, v161
    v_mfma_f32_16x16x32_bf16 v[80:83], a[64:67], v[152:155], v[80:83]
    ds_read_b64_tr_b16 v[144:145], v40 offset:23552
    v_log_f32 v169, v161
    v_mfma_f32_16x16x32_bf16 v[92:95], v[152:155], a[68:71], v[92:95]
    ds_read_b64_tr_b16 v[146:147], v40 offset:24064
    v_mov_b32 v171, v168
    v_mfma_f32_16x16x32_bf16 v[72:75], a[60:63], v[156:159], v[72:75]
    ds_write_b128 v54, v[168:171]
    v_mfma_f32_16x16x32_bf16 v[84:87], a[64:67], v[156:159], v[84:87]
    ds_read_b64_tr_b16 v[148:149], v41 offset:8192
    ds_write_b16 v55, v162
    v_mfma_f32_16x16x32_bf16 v[96:99], v[156:159], a[68:71], v[96:99]
    s_waitcnt lgkmcnt(9)
    ds_read_b64_tr_b16 v[150:151], v41 offset:8704
    ds_read_b64 v[172:173], v56 offset:8
    v_mfma_f32_16x16x32_bf16 v[76:79], a[76:79], v[124:127], v[76:79]
    ds_read_b64_tr_b16 v[152:153], v40 offset:8192
    ds_read_b64 v[174:175], v56 offset:264
    v_mfma_f32_16x16x32_bf16 v[88:91], v[124:127], a[80:83], v[88:91]
    ds_read_b64_tr_b16 v[154:155], v40 offset:8704
    ds_read_b64 v[176:177], v56 offset:520
    v_mfma_f32_16x16x32_bf16 v[68:71], a[72:75], v[128:131], v[68:71]
    ds_read2_b32 v[178:179], v57 offset0:2 offset1:6
    buffer_load_dwordx4 a[164:167], v4, s[4:7], s32 offen offset:2048
    v_mfma_f32_16x16x32_bf16 v[80:83], a[76:79], v[128:131], v[80:83]
    s_add_u32 s32, s34, 1835008
    ds_read_b64_tr_b16 v[156:157], v40 offset:24576
    ds_read2_b32 v[180:181], v57 offset0:10 offset1:14
    v_mfma_f32_16x16x32_bf16 v[92:95], v[128:131], a[80:83], v[92:95]
    ds_read_b64_tr_b16 v[158:159], v40 offset:25088
    ds_read2_b32 v[182:183], v57 offset0:66 offset1:70
    v_mfma_f32_16x16x32_bf16 v[72:75], a[72:75], v[132:135], v[72:75]
    ds_read2_b32 v[184:185], v57 offset0:74 offset1:78
    v_mfma_f32_16x16x32_bf16 v[84:87], a[76:79], v[132:135], v[84:87]
    ds_read_b64_tr_b16 v[124:125], v41 offset:9216
    ds_read2_b32 v[186:187], v57 offset0:130 offset1:134
    v_mfma_f32_16x16x32_bf16 v[96:99], v[132:135], a[80:83], v[96:99]
    s_waitcnt lgkmcnt(15)
    ds_read_b64_tr_b16 v[126:127], v41 offset:9728
    ds_read2_b32 v[188:189], v57 offset0:138 offset1:142
    v_mfma_f32_16x16x32_bf16 v[76:79], a[88:91], v[136:139], v[76:79]
    ds_read_b64_tr_b16 v[128:129], v40 offset:9216
    buffer_load_dwordx4 a[168:171], v4, s[4:7], s32 offen offset:0
    v_mfma_f32_16x16x32_bf16 v[88:91], v[136:139], a[92:95], v[88:91]
    ds_read_b64_tr_b16 v[130:131], v40 offset:9728
    v_mfma_f32_16x16x32_bf16 v[68:71], a[84:87], v[140:143], v[68:71]
    v_mfma_f32_16x16x32_bf16 v[80:83], a[88:91], v[140:143], v[80:83]
    ds_read_b64_tr_b16 v[132:133], v40 offset:25600
    v_mfma_f32_16x16x32_bf16 v[92:95], v[140:143], a[92:95], v[92:95]
    s_add_u32 s36, s64, 1048576
    s_add_u32 s38, s36, 16384
    ds_read_b64_tr_b16 v[134:135], v40 offset:26112
    v_mfma_f32_16x16x32_bf16 v[72:75], a[84:87], v[144:147], v[72:75]
    s_sub_u32 s37, s36, 16384
    s_add_u32 m0, s66, 81920
    buffer_load_dwordx4 a[172:175], v4, s[4:7], s32 offen offset:1024
    v_mfma_f32_16x16x32_bf16 v[84:87], a[88:91], v[144:147], v[84:87]
    ds_read_b64_tr_b16 v[136:137], v41 offset:10240
    buffer_load_dwordx4 v4, s[4:7], s37 offen offset:0 sc1 lds
    v_mfma_f32_16x16x32_bf16 v[96:99], v[144:147], a[92:95], v[96:99]
    s_waitcnt lgkmcnt(11)
    s_add_u32 m0, s66, 32768
    ds_read_b64_tr_b16 v[138:139], v41 offset:10752
    v_mfma_f32_16x16x32_bf16 v[76:79], a[100:103], v[148:151], v[76:79]
    ds_read_b64_tr_b16 v[140:141], v40 offset:10240
    v_mfma_f32_16x16x32_bf16 v[88:91], v[148:151], a[104:107], v[88:91]
    ds_read_b64_tr_b16 v[142:143], v40 offset:10752
    buffer_load_dwordx4 a[176:179], v4, s[4:7], s32 offen offset:2048
    v_mfma_f32_16x16x32_bf16 v[68:71], a[96:99], v[152:155], v[68:71]
    s_add_u32 s32, s34, 1966080
    buffer_load_dwordx4 v4, s[4:7], s36 offen offset:0 sc1 lds
    s_add_u32 m0, s66, 49152
    v_mfma_f32_16x16x32_bf16 v[80:83], a[100:103], v[152:155], v[80:83]
    s_waitcnt lgkmcnt(8)
    ds_read_b64_tr_b16 v[144:145], v40 offset:26624
    v_mfma_f32_16x16x32_bf16 v[92:95], v[152:155], a[104:107], v[92:95]
    ds_read_b64_tr_b16 v[146:147], v40 offset:27136
    v_fma_f32 v76, -v24, v172, v76
    v_mfma_f32_16x16x32_bf16 v[72:75], a[96:99], v[156:159], v[72:75]
    buffer_load_dwordx4 a[180:183], v4, s[4:7], s32 offen offset:0
    v_fma_f32 v88, -v178, v28, v88
    v_mfma_f32_16x16x32_bf16 v[84:87], a[100:103], v[156:159], v[84:87]
    ds_read_b64_tr_b16 v[148:149], v41 offset:11264
    v_fma_f32 v68, -v20, v174, v68
    v_mfma_f32_16x16x32_bf16 v[96:99], v[156:159], a[104:107], v[96:99]
    s_waitcnt lgkmcnt(7)
    ds_read_b64_tr_b16 v[150:151], v41 offset:11776
    v_fma_f32 v80, -v24, v174, v80
    s_waitcnt vmcnt(19)
    v_mfma_f32_16x16x32_bf16 v[76:79], a[112:115], v[124:127], v[76:79]
    ds_read_b64_tr_b16 v[152:153], v40 offset:11264
    v_fma_f32 v92, -v182, v28, v92
    s_waitcnt vmcnt(18)
    v_mfma_f32_16x16x32_bf16 v[88:91], v[124:127], a[116:119], v[88:91]
    ds_read_b64_tr_b16 v[154:155], v40 offset:11776
    v_fma_f32 v72, -v20, v176, v72
    v_mfma_f32_16x16x32_bf16 v[68:71], a[108:111], v[128:131], v[68:71]
    buffer_load_dwordx4 v4, s[4:7], s38 offen offset:0 sc1 lds
    v_fma_f32 v84, -v24, v176, v84
    v_mfma_f32_16x16x32_bf16 v[80:83], a[112:115], v[128:131], v[80:83]
    s_add_u32 m0, s66, 81920
    ds_read_b64_tr_b16 v[156:157], v40 offset:27648
    v_fma_f32 v96, -v186, v28, v96
    v_mfma_f32_16x16x32_bf16 v[92:95], v[128:131], a[116:119], v[92:95]
    ds_read_b64_tr_b16 v[158:159], v40 offset:28160
    v_fma_f32 v77, -v25, v172, v77
    v_mfma_f32_16x16x32_bf16 v[72:75], a[108:111], v[132:135], v[72:75]
    buffer_load_dwordx4 a[184:187], v4, s[4:7], s32 offen offset:1024
    v_fma_f32 v89, -v179, v28, v89
    v_mfma_f32_16x16x32_bf16 v[84:87], a[112:115], v[132:135], v[84:87]
    ds_read_b64_tr_b16 v[124:125], v41 offset:12288
    v_fma_f32 v69, -v21, v174, v69
    v_mfma_f32_16x16x32_bf16 v[96:99], v[132:135], a[116:119], v[96:99]
    s_waitcnt lgkmcnt(7)
    ds_read_b64_tr_b16 v[126:127], v41 offset:12800
    v_fma_f32 v81, -v25, v174, v81
    s_waitcnt vmcnt(18)
    v_mfma_f32_16x16x32_bf16 v[76:79], a[124:127], v[136:139], v[76:79]
    ds_read_b64_tr_b16 v[128:129], v40 offset:12288
    v_fma_f32 v93, -v183, v28, v93
    s_waitcnt vmcnt(17)
    v_mfma_f32_16x16x32_bf16 v[88:91], v[136:139], a[128:131], v[88:91]
    ds_read_b64_tr_b16 v[130:131], v40 offset:12800
    v_fma_f32 v73, -v21, v176, v73
    v_mfma_f32_16x16x32_bf16 v[68:71], a[120:123], v[140:143], v[68:71]
    buffer_load_dwordx4 v4, s[4:7], s37 offen offset:1024 sc1 lds
    v_fma_f32 v85, -v25, v176, v85
    v_mfma_f32_16x16x32_bf16 v[80:83], a[124:127], v[140:143], v[80:83]
    s_add_u32 m0, s66, 32768
    ds_read_b64_tr_b16 v[132:133], v40 offset:28672
    v_fma_f32 v97, -v187, v28, v97
    v_mfma_f32_16x16x32_bf16 v[92:95], v[140:143], a[128:131], v[92:95]
    ds_read_b64_tr_b16 v[134:135], v40 offset:29184
    v_fma_f32 v78, -v26, v172, v78
    v_mfma_f32_16x16x32_bf16 v[72:75], a[120:123], v[144:147], v[72:75]
    buffer_load_dwordx4 a[188:191], v4, s[4:7], s32 offen offset:2048
    v_fma_f32 v90, -v180, v28, v90
    v_mfma_f32_16x16x32_bf16 v[84:87], a[124:127], v[144:147], v[84:87]
    ds_read_b64_tr_b16 v[136:137], v41 offset:13312
    v_fma_f32 v70, -v22, v174, v70
    v_mfma_f32_16x16x32_bf16 v[96:99], v[144:147], a[128:131], v[96:99]
    s_waitcnt lgkmcnt(7)
    ds_read_b64_tr_b16 v[138:139], v41 offset:13824
    v_fma_f32 v82, -v26, v174, v82
    s_waitcnt vmcnt(17)
    v_mfma_f32_16x16x32_bf16 v[76:79], a[136:139], v[148:151], v[76:79]
    ds_read_b64_tr_b16 v[140:141], v40 offset:13312
    v_fma_f32 v94, -v184, v28, v94
    s_waitcnt vmcnt(16)
    v_mfma_f32_16x16x32_bf16 v[88:91], v[148:151], a[140:143], v[88:91]
    ds_read_b64_tr_b16 v[142:143], v40 offset:13824
    v_fma_f32 v74, -v22, v176, v74
    v_mfma_f32_16x16x32_bf16 v[68:71], a[132:135], v[152:155], v[68:71]
    buffer_load_dwordx4 v4, s[4:7], s36 offen offset:1024 sc1 lds
    v_fma_f32 v86, -v26, v176, v86
    v_mfma_f32_16x16x32_bf16 v[80:83], a[136:139], v[152:155], v[80:83]
    s_add_u32 m0, s66, 49152
    ds_read_b64_tr_b16 v[144:145], v40 offset:29696
    v_fma_f32 v98, -v188, v28, v98
    v_mfma_f32_16x16x32_bf16 v[92:95], v[152:155], a[140:143], v[92:95]
    ds_read_b64_tr_b16 v[146:147], v40 offset:30208
    v_fma_f32 v79, -v27, v172, v79
    v_mfma_f32_16x16x32_bf16 v[72:75], a[132:135], v[156:159], v[72:75]
    v_fma_f32 v91, -v181, v28, v91
    v_mfma_f32_16x16x32_bf16 v[84:87], a[136:139], v[156:159], v[84:87]
    ds_read_b64_tr_b16 v[148:149], v41 offset:14336
    v_fma_f32 v71, -v23, v174, v71
    v_mfma_f32_16x16x32_bf16 v[96:99], v[156:159], a[140:143], v[96:99]
    s_waitcnt lgkmcnt(7)
    ds_read_b64_tr_b16 v[150:151], v41 offset:14848
    v_fma_f32 v83, -v27, v174, v83
    s_waitcnt vmcnt(15)
    v_mfma_f32_16x16x32_bf16 v[76:79], a[148:151], v[124:127], v[76:79]
    ds_read_b64_tr_b16 v[152:153], v40 offset:14336
    v_fma_f32 v95, -v185, v28, v95
    s_waitcnt vmcnt(14)
    v_mfma_f32_16x16x32_bf16 v[88:91], v[124:127], a[152:155], v[88:91]
    ds_read_b64_tr_b16 v[154:155], v40 offset:14848
    v_fma_f32 v75, -v23, v176, v75
    v_mfma_f32_16x16x32_bf16 v[68:71], a[144:147], v[128:131], v[68:71]
    buffer_load_dwordx4 v4, s[4:7], s38 offen offset:1024 sc1 lds
    v_fma_f32 v87, -v27, v176, v87
    v_mfma_f32_16x16x32_bf16 v[80:83], a[148:151], v[128:131], v[80:83]
    s_add_u32 m0, s66, 81920
    ds_read_b64_tr_b16 v[156:157], v40 offset:30720
    v_fma_f32 v99, -v189, v28, v99
    v_mfma_f32_16x16x32_bf16 v[92:95], v[128:131], a[152:155], v[92:95]
    ds_read_b64_tr_b16 v[158:159], v40 offset:31232
    v_mfma_f32_16x16x32_bf16 v[72:75], a[144:147], v[132:135], v[72:75]
    ds_read_b64 v[240:241], v45 offset:0
    v_mfma_f32_16x16x32_bf16 v[84:87], a[148:151], v[132:135], v[84:87]
    ds_read_b64_tr_b16 v[124:125], v41 offset:15360
    buffer_load_dwordx4 v4, s[4:7], s37 offen offset:2048 sc1 lds
    v_mfma_f32_16x16x32_bf16 v[96:99], v[132:135], a[152:155], v[96:99]
    s_waitcnt lgkmcnt(8)
    s_add_u32 m0, s66, 32768
    ds_read_b64_tr_b16 v[126:127], v41 offset:15872
    s_waitcnt vmcnt(14)
    v_mfma_f32_16x16x32_bf16 v[76:79], a[160:163], v[136:139], v[76:79]
    ds_read_b64_tr_b16 v[128:129], v40 offset:15360
    s_waitcnt vmcnt(13)
    v_mfma_f32_16x16x32_bf16 v[88:91], v[136:139], a[164:167], v[88:91]
    ds_read_b64_tr_b16 v[130:131], v40 offset:15872
    v_mfma_f32_16x16x32_bf16 v[68:71], a[156:159], v[140:143], v[68:71]
    buffer_load_dwordx4 v4, s[4:7], s36 offen offset:2048 sc1 lds
    s_add_u32 m0, s66, 49152
    v_mfma_f32_16x16x32_bf16 v[80:83], a[160:163], v[140:143], v[80:83]
    ds_read_b64_tr_b16 v[132:133], v40 offset:31744
    v_mfma_f32_16x16x32_bf16 v[92:95], v[140:143], a[164:167], v[92:95]
    ds_read_b64_tr_b16 v[134:135], v40 offset:32256
    v_mfma_f32_16x16x32_bf16 v[72:75], a[156:159], v[144:147], v[72:75]
    ds_read_b64 v[242:243], v45 offset:16384
    v_mfma_f32_16x16x32_bf16 v[84:87], a[160:163], v[144:147], v[84:87]
    buffer_load_dwordx4 v4, s[4:7], s38 offen offset:2048 sc1 lds
    s_add_u32 m0, s66, 81920
    v_mfma_f32_16x16x32_bf16 v[96:99], v[144:147], a[164:167], v[96:99]
    s_waitcnt lgkmcnt(8)
    s_waitcnt vmcnt(13)
    v_mfma_f32_16x16x32_bf16 v[76:79], a[172:175], v[148:151], v[76:79]
    ds_read_b64 v[190:191], v58 offset:0
    s_waitcnt vmcnt(11)
    v_mfma_f32_16x16x32_bf16 v[88:91], v[148:151], a[176:179], v[88:91]
    ds_read_b64 v[192:193], v59 offset:0
    v_mfma_f32_16x16x32_bf16 v[68:71], a[168:171], v[152:155], v[68:71]
    buffer_load_dwordx4 v4, s[4:7], s37 offen offset:3072 sc1 lds
    s_add_u32 m0, s66, 32768
    v_mfma_f32_16x16x32_bf16 v[80:83], a[172:175], v[152:155], v[80:83]
    ds_read_b64 v[194:195], v58 offset:256
    v_mfma_f32_16x16x32_bf16 v[92:95], v[152:155], a[176:179], v[92:95]
    ds_read_b64 v[196:197], v59 offset:256
    v_mfma_f32_16x16x32_bf16 v[72:75], a[168:171], v[156:159], v[72:75]
    ds_read_b64 v[198:199], v60 offset:0
    v_mfma_f32_16x16x32_bf16 v[84:87], a[172:175], v[156:159], v[84:87]
    buffer_load_dwordx4 v4, s[4:7], s36 offen offset:3072 sc1 lds
    s_add_u32 m0, s66, 49152
    v_mfma_f32_16x16x32_bf16 v[96:99], v[156:159], a[176:179], v[96:99]
    s_waitcnt lgkmcnt(6)
    ds_read_b64 v[200:201], v60 offset:32
    s_waitcnt vmcnt(9)
    v_mfma_f32_16x16x32_bf16 v[76:79], a[184:187], v[124:127], v[76:79]
    ds_read_b64 v[202:203], v60 offset:64
    s_waitcnt vmcnt(7)
    v_mfma_f32_16x16x32_bf16 v[88:91], v[124:127], a[188:191], v[88:91]
    v_mfma_f32_16x16x32_bf16 v[68:71], a[180:183], v[128:131], v[68:71]
    buffer_load_dwordx4 v4, s[4:7], s38 offen offset:3072 sc1 lds
    v_mfma_f32_16x16x32_bf16 v[80:83], a[184:187], v[128:131], v[80:83]
    v_mfma_f32_16x16x32_bf16 v[92:95], v[128:131], a[188:191], v[92:95]
    v_mfma_f32_16x16x32_bf16 v[72:75], a[180:183], v[132:135], v[72:75]
    v_mfma_f32_16x16x32_bf16 v[84:87], a[184:187], v[132:135], v[84:87]
    v_mfma_f32_16x16x32_bf16 v[96:99], v[132:135], a[188:191], v[96:99]
    s_waitcnt vmcnt(6)
    ds_read_b64_tr_b16 v[124:125], v43 offset:16384
    ds_read_b64_tr_b16 v[126:127], v43 offset:16896
    ds_read_b64_tr_b16 v[128:129], v42 offset:32768
    ds_read_b64_tr_b16 v[130:131], v42 offset:33280
    ds_read_b64_tr_b16 v[132:133], v42 offset:49152
    ds_read_b64_tr_b16 v[134:135], v42 offset:49664
    ds_read_b64_tr_b16 v[136:137], v43 offset:17408
    ds_read_b64_tr_b16 v[138:139], v43 offset:17920
    ds_read_b64_tr_b16 v[140:141], v42 offset:33792
    ds_read_b64_tr_b16 v[142:143], v42 offset:34304
    ds_read_b64_tr_b16 v[144:145], v42 offset:50176
    ds_read_b64_tr_b16 v[146:147], v42 offset:50688
    v_cvt_pk_bf16_f32 v210, v76, v77
    v_cvt_pk_bf16_f32 v211, v78, v79
    v_cvt_pk_bf16_f32 v212, v80, v81
    v_cvt_pk_bf16_f32 v213, v82, v83
    v_cvt_pk_bf16_f32 v206, v68, v69
    v_cvt_pk_bf16_f32 v207, v70, v71
    v_cvt_pk_bf16_f32 v214, v84, v85
    v_cvt_pk_bf16_f32 v215, v86, v87
    v_cvt_pk_bf16_f32 v208, v72, v73
    v_cvt_pk_bf16_f32 v209, v74, v75
    s_waitcnt lgkmcnt(10)
    v_mfma_f32_16x16x32_bf16 v[112:115], v[16:19], v[124:127], 0
    s_waitcnt vmcnt(0)
    ds_read_b64_tr_b16 v[148:149], v43 offset:18432
    ds_read_b64_tr_b16 v[150:151], v43 offset:18944
    s_waitcnt lgkmcnt(10)
    v_mfma_f32_16x16x32_bf16 v[116:119], v[16:19], v[128:131], 0
    ds_read_b64_tr_b16 v[152:153], v42 offset:34816
    ds_read_b64_tr_b16 v[154:155], v42 offset:35328
    s_waitcnt lgkmcnt(10)
    v_mfma_f32_16x16x32_bf16 v[120:123], v[16:19], v[132:135], 0
    ds_read_b64_tr_b16 v[156:157], v42 offset:51200
    ds_read_b64_tr_b16 v[158:159], v42 offset:51712
    v_mfma_f32_16x16x32_bf16 v[100:103], v[124:127], v[124:127], 0
    ds_read_b64_tr_b16 v[178:179], v43 offset:19456
    ds_read_b64_tr_b16 v[180:181], v43 offset:19968
    v_mfma_f32_16x16x32_bf16 v[104:107], v[128:131], v[128:131], 0
    ds_read_b64_tr_b16 v[182:183], v42 offset:35840
    ds_read_b64_tr_b16 v[184:185], v42 offset:36352
    v_mfma_f32_16x16x32_bf16 v[108:111], v[132:135], v[132:135], 0
    s_waitcnt lgkmcnt(10)
    ds_read_b64_tr_b16 v[186:187], v42 offset:52224
    ds_read_b64_tr_b16 v[188:189], v42 offset:52736
    v_mfma_f32_16x16x32_bf16 v[112:115], v[16:19], v[136:139], v[112:115]
    v_cvt_pk_bf16_f32 v216, v88, v89
    v_cvt_pk_bf16_f32 v217, v90, v91
    v_mfma_f32_16x16x32_bf16 v[116:119], v[16:19], v[140:143], v[116:119]
    v_cvt_pk_bf16_f32 v218, v92, v93
    v_cvt_pk_bf16_f32 v219, v94, v95
    v_mfma_f32_16x16x32_bf16 v[120:123], v[16:19], v[144:147], v[120:123]
    s_waitcnt lgkmcnt(6)
    v_cvt_pk_bf16_f32 v220, v96, v97
    v_cvt_pk_bf16_f32 v221, v98, v99
    v_mfma_f32_16x16x32_bf16 v[112:115], v[16:19], v[148:151], v[112:115]
    v_mul_f32 v204, s30, v175
    v_mul_f32 v205, s30, v177
    v_mfma_f32_16x16x16_bf16 v[232:235], v[210:211], v[206:207], v[36:39]
    v_mfma_f32_16x16x16_bf16 v[224:227], v[212:213], v[206:207], 0
    v_mfma_f32_16x16x16_bf16 v[236:239], v[212:213], v[208:209], 0
    v_mfma_f32_16x16x16_bf16 v[228:231], v[214:215], v[208:209], 0
    s_add_u32 s41, s73, 0
    v_mfma_f32_16x16x32_bf16 v[116:119], v[16:19], v[152:155], v[116:119]
    s_nop 2
    v_cndmask_b32 v232, v232, v233, s[54:55]
    v_cndmask_b32 v234, v234, v235, s[54:55]
    v_mfma_f32_16x16x32_bf16 v[120:123], v[16:19], v[156:159], v[120:123]
    s_waitcnt lgkmcnt(0)
    v_cndmask_b32 v224, v224, v225, s[54:55]
    v_cndmask_b32 v226, v226, v227, s[54:55]
    v_mfma_f32_16x16x32_bf16 v[112:115], v[16:19], v[178:181], v[112:115]
    v_cndmask_b32 v236, v236, v237, s[54:55]
    v_cndmask_b32 v238, v238, v239, s[54:55]
    v_mfma_f32_16x16x32_bf16 v[116:119], v[16:19], v[182:185], v[116:119]
    v_cndmask_b32 v228, v228, v229, s[54:55]
    v_cndmask_b32 v230, v230, v231, s[54:55]
    v_mfma_f32_16x16x32_bf16 v[120:123], v[16:19], v[186:189], v[120:123]
    v_cndmask_b32 v224, v232, v224, s[56:57]
    v_cndmask_b32 v225, v234, v226, s[58:59]
    v_mfma_f32_16x16x32_bf16 v[100:103], v[136:139], v[136:139], v[100:103]
    v_cndmask_b32 v228, v236, v228, s[56:57]
    v_cndmask_b32 v229, v238, v230, s[58:59]
    v_mfma_f32_16x16x32_bf16 v[104:107], v[140:143], v[140:143], v[104:107]
    v_mul_f32 v224, v224, v190
    v_mul_f32 v225, v225, v192
    v_mfma_f32_16x16x32_bf16 v[108:111], v[144:147], v[144:147], v[108:111]
    v_add_f32 v252, v112, v116
    v_cmp_u_f32 vcc, v252, v120
    v_mfma_f32_16x16x32_bf16 v[100:103], v[148:151], v[148:151], v[100:103]
    s_cbranch_vccnz sr01
so01:
    v_mul_f32 v228, v228, v194
    v_mfma_f32_16x16x32_bf16 v[104:107], v[152:155], v[152:155], v[104:107]
    s_barrier
    ds_read_b64_tr_b16 v[124:125], v41 offset:16384
    ds_read_b64_tr_b16 v[126:127], v41 offset:16896
    v_mfma_f32_16x16x32_bf16 v[108:111], v[156:159], v[156:159], v[108:111]
    ds_read_b64_tr_b16 v[128:129], v40 offset:32768
    ds_read_b64_tr_b16 v[130:131], v40 offset:33280
    v_mfma_f32_16x16x32_bf16 v[100:103], v[178:181], v[178:181], v[100:103]
    ds_read_b64_tr_b16 v[132:133], v40 offset:49152
    ds_read_b64_tr_b16 v[134:135], v40 offset:49664
    v_mfma_f32_16x16x32_bf16 v[104:107], v[182:185], v[182:185], v[104:107]
    ds_read_b64_tr_b16 v[136:137], v41 offset:17408
    ds_read_b64_tr_b16 v[138:139], v41 offset:17920
    v_mfma_f32_16x16x32_bf16 v[108:111], v[186:189], v[186:189], v[108:111]
    ds_read_b64_tr_b16 v[140:141], v40 offset:33792
    ds_read_b64_tr_b16 v[142:143], v40 offset:34304
    ds_read_b64_tr_b16 v[144:145], v40 offset:50176
    ds_read_b64_tr_b16 v[146:147], v40 offset:50688
    s_waitcnt lgkmcnt(10)
    v_mfma_f32_16x16x32_bf16 v[76:79], a[4:7], v[124:127], 0
    s_add_u32 s61, s75, 6291456
    ds_read_b64_tr_b16 v[148:149], v41 offset:18432
    v_mul_f32 v229, v229, v196
    v_mfma_f32_16x16x32_bf16 v[88:91], v[124:127], a[8:11], 0
    ds_read_b64_tr_b16 v[150:151], v41 offset:18944
    v_max_f32 v222, v224, v225
    s_waitcnt lgkmcnt(10)
    v_mfma_f32_16x16x32_bf16 v[68:71], a[0:3], v[128:131], 0
    ds_read_b64_tr_b16 v[152:153], v40 offset:34816
    v_max_f32 v223, v228, v229
    v_mfma_f32_16x16x32_bf16 v[80:83], a[4:7], v[128:131], 0
    ds_read_b64_tr_b16 v[154:155], v40 offset:35328
    v_permlane16_swap_b32 v222, v223
    v_mfma_f32_16x16x32_bf16 v[92:95], v[128:131], a[8:11], 0
    ds_read_b64_tr_b16 v[156:157], v40 offset:51200
    v_max_f32 v222, v222, v223
    s_waitcnt lgkmcnt(11)
    v_mfma_f32_16x16x32_bf16 v[72:75], a[0:3], v[132:135], 0
    ds_read_b64_tr_b16 v[158:159], v40 offset:51712
    v_mov_b32 v223, v222
    v_mfma_f32_16x16x32_bf16 v[84:87], a[4:7], v[132:135], 0
    ds_read_b64_tr_b16 v[124:125], v41 offset:19456
    v_permlane32_swap_b32 v222, v223
    v_mfma_f32_16x16x32_bf16 v[96:99], v[132:135], a[8:11], 0
    s_waitcnt lgkmcnt(7)
    ds_read_b64_tr_b16 v[126:127], v41 offset:19968
    v_max_f32 v222, v222, v223
    v_mfma_f32_16x16x32_bf16 v[76:79], a[16:19], v[136:139], v[76:79]
    ds_read_b64_tr_b16 v[128:129], v40 offset:35840
    v_mov_b32 v223, v222
    v_mfma_f32_16x16x32_bf16 v[88:91], v[136:139], a[20:23], v[88:91]
    ds_read_b64_tr_b16 v[130:131], v40 offset:36352
    v_permlane16_swap_b32 v222, v223
    v_mfma_f32_16x16x32_bf16 v[68:71], a[12:15], v[140:143], v[68:71]
    v_sub_f32 v224, v224, v222
    v_sub_f32 v225, v225, v222
    v_mfma_f32_16x16x32_bf16 v[80:83], a[16:19], v[140:143], v[80:83]
    ds_read_b64_tr_b16 v[132:133], v40 offset:52224
    v_sub_f32 v228, v228, v223
    v_mfma_f32_16x16x32_bf16 v[92:95], v[140:143], a[20:23], v[92:95]
    ds_read_b64_tr_b16 v[134:135], v40 offset:52736
    v_sub_f32 v229, v229, v223
    v_mfma_f32_16x16x32_bf16 v[72:75], a[12:15], v[144:147], v[72:75]
    v_fma_f32 v224, v224, v204, -v191
    v_fma_f32 v225, v225, v204, -v193
    v_mfma_f32_16x16x32_bf16 v[84:87], a[16:19], v[144:147], v[84:87]
    ds_read_b64_tr_b16 v[136:137], v41 offset:20480
    v_fma_f32 v228, v228, v205, -v195
    v_mfma_f32_16x16x32_bf16 v[96:99], v[144:147], a[20:23], v[96:99]
    s_waitcnt lgkmcnt(7)
    ds_read_b64_tr_b16 v[138:139], v41 offset:20992
    v_fma_f32 v229, v229, v205, -v197
    v_mfma_f32_16x16x32_bf16 v[76:79], a[28:31], v[148:151], v[76:79]
    ds_read_b64_tr_b16 v[140:141], v40 offset:36864
    v_exp_f32 v224, v224
    v_mfma_f32_16x16x32_bf16 v[88:91], v[148:151], a[32:35], v[88:91]
    ds_read_b64_tr_b16 v[142:143], v40 offset:37376
    v_exp_f32 v225, v225
    v_mfma_f32_16x16x32_bf16 v[68:71], a[24:27], v[152:155], v[68:71]
    v_exp_f32 v228, v228
    v_exp_f32 v229, v229
    v_mfma_f32_16x16x32_bf16 v[80:83], a[28:31], v[152:155], v[80:83]
    ds_read_b64_tr_b16 v[144:145], v40 offset:53248
    v_cvt_pk_bf16_f32 v224, v224, v224
    v_mfma_f32_16x16x32_bf16 v[92:95], v[152:155], a[32:35], v[92:95]
    ds_read_b64_tr_b16 v[146:147], v40 offset:53760
    v_cvt_pk_bf16_f32 v225, v225, v225
    v_mfma_f32_16x16x32_bf16 v[72:75], a[24:27], v[156:159], v[72:75]
    v_cvt_pk_bf16_f32 v228, v228, v228
    v_cvt_pk_bf16_f32 v229, v229, v229
    v_mfma_f32_16x16x32_bf16 v[84:87], a[28:31], v[156:159], v[84:87]
    ds_read_b64_tr_b16 v[148:149], v41 offset:21504
    v_and_b32 v232, v224, v32
    v_mfma_f32_16x16x32_bf16 v[96:99], v[156:159], a[32:35], v[96:99]
    s_waitcnt lgkmcnt(7)
    ds_read_b64_tr_b16 v[150:151], v41 offset:22016
    v_and_b32 v233, v225, v33
    v_mfma_f32_16x16x32_bf16 v[76:79], a[40:43], v[124:127], v[76:79]
    ds_read_b64_tr_b16 v[152:153], v40 offset:37888
    v_and_b32 v234, v224, v34
    v_mfma_f32_16x16x32_bf16 v[88:91], v[124:127], a[44:47], v[88:91]
    ds_read_b64_tr_b16 v[154:155], v40 offset:38400
    v_and_b32 v235, v225, v35
    v_mfma_f32_16x16x32_bf16 v[68:71], a[36:39], v[128:131], v[68:71]
    v_and_b32 v236, v228, v32
    v_and_b32 v237, v229, v33
    v_mfma_f32_16x16x32_bf16 v[80:83], a[40:43], v[128:131], v[80:83]
    ds_read_b64_tr_b16 v[156:157], v40 offset:54272
    v_and_b32 v238, v228, v34
    v_mfma_f32_16x16x32_bf16 v[92:95], v[128:131], a[44:47], v[92:95]
    ds_read_b64_tr_b16 v[158:159], v40 offset:54784
    v_and_b32 v239, v229, v35
    v_mfma_f32_16x16x32_bf16 v[160:163], v[198:201], v[232:235], 0
    buffer_store_dwordx4 a[252:255], v5, s[4:7], s61 offen sc1
    v_cndmask_b32 v113, v100, v101, s[48:49]
    v_mfma_f32_16x16x32_bf16 v[164:167], v[200:203], v[236:239], 0
    s_add_u32 s61, s75, 7340032
    v_cndmask_b32 v113, v113, v102, s[50:51]
    v_mfma_f32_16x16x32_bf16 v[178:181], v[216:219], v[232:235], 0
    v_cndmask_b32 v113, v113, v103, s[52:53]
    v_mfma_f32_16x16x32_bf16 v[182:185], v[218:221], v[236:239], 0
    v_cndmask_b32 v117, v104, v105, s[48:49]
    v_mfma_f32_16x16x32_bf16 v[72:75], a[36:39], v[132:135], v[72:75]
    v_rcp_f32 v160, v160
    v_cndmask_b32 v117, v117, v106, s[50:51]
    v_mfma_f32_16x16x32_bf16 v[84:87], a[40:43], v[132:135], v[84:87]
    ds_read_b64_tr_b16 v[124:125], v41 offset:22528
    v_rcp_f32 v164, v164
    v_mfma_f32_16x16x32_bf16 v[96:99], v[132:135], a[44:47], v[96:99]
    s_waitcnt lgkmcnt(7)
    ds_read_b64_tr_b16 v[126:127], v41 offset:23040
    v_mul_f32 v178, v178, v160
    v_mfma_f32_16x16x32_bf16 v[76:79], a[52:55], v[136:139], v[76:79]
    ds_read_b64_tr_b16 v[128:129], v40 offset:38912
    v_mul_f32 v179, v179, v160
    v_mfma_f32_16x16x32_bf16 v[88:91], v[136:139], a[56:59], v[88:91]
    ds_read_b64_tr_b16 v[130:131], v40 offset:39424
    v_mul_f32 v180, v180, v160
    v_mfma_f32_16x16x32_bf16 v[68:71], a[48:51], v[140:143], v[68:71]
    v_mul_f32 v181, v181, v160
    v_mul_f32 v182, v182, v164
    v_mfma_f32_16x16x32_bf16 v[80:83], a[52:55], v[140:143], v[80:83]
    ds_read_b64_tr_b16 v[132:133], v40 offset:55296
    v_mul_f32 v183, v183, v164
    v_mfma_f32_16x16x32_bf16 v[92:95], v[140:143], a[56:59], v[92:95]
    ds_read_b64_tr_b16 v[134:135], v40 offset:55808
    v_mul_f32 v184, v184, v164
    v_mfma_f32_16x16x32_bf16 v[72:75], a[48:51], v[144:147], v[72:75]
    v_mul_f32 v185, v185, v164
    v_cvt_pk_bf16_f32 v224, v178, v179
    v_mfma_f32_16x16x32_bf16 v[84:87], a[52:55], v[144:147], v[84:87]
    ds_read_b64_tr_b16 v[136:137], v41 offset:23552
    v_cvt_pk_bf16_f32 v225, v180, v181
    v_mfma_f32_16x16x32_bf16 v[96:99], v[144:147], a[56:59], v[96:99]
    s_waitcnt lgkmcnt(7)
    ds_read_b64_tr_b16 v[138:139], v41 offset:24064
    v_cvt_pk_bf16_f32 v226, v182, v183
    v_mfma_f32_16x16x32_bf16 v[76:79], a[64:67], v[148:151], v[76:79]
    ds_read_b64_tr_b16 v[140:141], v40 offset:39936
    v_cvt_pk_bf16_f32 v227, v184, v185
    v_mfma_f32_16x16x32_bf16 v[88:91], v[148:151], a[68:71], v[88:91]
    ds_read_b64_tr_b16 v[142:143], v40 offset:40448
    v_permlane16_swap_b32 v224, v226
    v_mfma_f32_16x16x32_bf16 v[68:71], a[60:63], v[152:155], v[68:71]
    v_permlane16_swap_b32 v225, v227
    v_cndmask_b32 v117, v117, v107, s[52:53]
    v_mfma_f32_16x16x32_bf16 v[80:83], a[64:67], v[152:155], v[80:83]
    ds_read_b64_tr_b16 v[144:145], v40 offset:56320
    buffer_store_dwordx4 v[224:227], v44, s[4:7], s41 offen sc1
    v_mfma_f32_16x16x32_bf16 v[92:95], v[152:155], a[68:71], v[92:95]
    ds_read_b64_tr_b16 v[146:147], v40 offset:56832
    v_cndmask_b32 v121, v108, v109, s[48:49]
    v_mfma_f32_16x16x32_bf16 v[72:75], a[60:63], v[156:159], v[72:75]
    buffer_store_dwordx4 a[252:255], v5, s[4:7], s61 offen sc1
    v_cndmask_b32 v121, v121, v110, s[50:51]
    v_mfma_f32_16x16x32_bf16 v[84:87], a[64:67], v[156:159], v[84:87]
    s_add_u32 s32, s34, 0
    ds_read_b64_tr_b16 v[148:149], v41 offset:24576
    v_cndmask_b32 v121, v121, v111, s[52:53]
    v_mfma_f32_16x16x32_bf16 v[96:99], v[156:159], a[68:71], v[96:99]
    s_waitcnt lgkmcnt(7)
    ds_read_b64_tr_b16 v[150:151], v41 offset:25088
    ds_write_b64 v52, v[112:113] offset:0
    v_mfma_f32_16x16x32_bf16 v[76:79], a[76:79], v[124:127], v[76:79]
    ds_read_b64_tr_b16 v[152:153], v40 offset:40960
    ds_write_b64 v52, v[116:117] offset:128
    v_mfma_f32_16x16x32_bf16 v[88:91], v[124:127], a[80:83], v[88:91]
    ds_read_b64_tr_b16 v[154:155], v40 offset:41472
    ds_write_b64 v52, v[120:121] offset:256
    v_mfma_f32_16x16x32_bf16 v[68:71], a[72:75], v[128:131], v[68:71]
    buffer_load_dwordx4 a[192:195], v4, s[4:7], s32 offen offset:3072
    s_add_u32 s32, s34, 131072
    v_mfma_f32_16x16x32_bf16 v[80:83], a[76:79], v[128:131], v[80:83]
    ds_read_b64_tr_b16 v[156:157], v40 offset:57344
    v_mfma_f32_16x16x32_bf16 v[92:95], v[128:131], a[80:83], v[92:95]
    s_waitcnt lgkmcnt(1)
    s_barrier
    ds_read_b64_tr_b16 v[158:159], v40 offset:57856
    v_mfma_f32_16x16x32_bf16 v[72:75], a[72:75], v[132:135], v[72:75]
iw3:
    s_cbranch_execz iw7
    ds_read_b64 v[160:161], v53 offset:0
    v_mfma_f32_16x16x32_bf16 v[84:87], a[76:79], v[132:135], v[84:87]
    ds_read_b64_tr_b16 v[124:125], v41 offset:25600
    ds_read_b64 v[162:163], v53 offset:512
    v_mfma_f32_16x16x32_bf16 v[96:99], v[132:135], a[80:83], v[96:99]
    ds_read_b64_tr_b16 v[126:127], v41 offset:26112
    ds_read_b64 v[164:165], v53 offset:1024
    v_mfma_f32_16x16x32_bf16 v[76:79], a[88:91], v[136:139], v[76:79]
    ds_read_b64_tr_b16 v[128:129], v40 offset:41984
    ds_read_b64 v[166:167], v53 offset:1536
    v_mfma_f32_16x16x32_bf16 v[88:91], v[136:139], a[92:95], v[88:91]
    ds_read_b64_tr_b16 v[130:131], v40 offset:42496
    buffer_load_dwordx4 a[196:199], v4, s[4:7], s32 offen offset:3072
    v_mfma_f32_16x16x32_bf16 v[68:71], a[84:87], v[140:143], v[68:71]
    s_add_u32 s32, s34, 262144
    v_mfma_f32_16x16x32_bf16 v[80:83], a[88:91], v[140:143], v[80:83]
    ds_read_b64_tr_b16 v[132:133], v40 offset:58368
    v_mfma_f32_16x16x32_bf16 v[92:95], v[140:143], a[92:95], v[92:95]
    s_waitcnt lgkmcnt(2)
    ds_read_b64_tr_b16 v[134:135], v40 offset:58880
    v_add_f32 v160, v160, v162
    v_mfma_f32_16x16x32_bf16 v[72:75], a[84:87], v[144:147], v[72:75]
    buffer_load_dwordx4 a[200:203], v4, s[4:7], s32 offen offset:3072
    v_add_f32 v161, v161, v163
    v_mfma_f32_16x16x32_bf16 v[84:87], a[88:91], v[144:147], v[84:87]
    s_add_u32 s32, s34, 393216
    ds_read_b64_tr_b16 v[136:137], v41 offset:26624
    v_add_f32 v164, v164, v166
    v_mfma_f32_16x16x32_bf16 v[96:99], v[144:147], a[92:95], v[96:99]
    ds_read_b64_tr_b16 v[138:139], v41 offset:27136
    v_add_f32 v165, v165, v167
    v_mfma_f32_16x16x32_bf16 v[76:79], a[100:103], v[148:151], v[76:79]
    ds_read_b64_tr_b16 v[140:141], v40 offset:43008
    v_add_f32 v160, v160, v164
    v_mfma_f32_16x16x32_bf16 v[88:91], v[148:151], a[104:107], v[88:91]
    ds_read_b64_tr_b16 v[142:143], v40 offset:43520
    v_add_f32 v161, v161, v165
    v_mfma_f32_16x16x32_bf16 v[68:71], a[96:99], v[152:155], v[68:71]
    buffer_load_dwordx4 a[204:207], v4, s[4:7], s32 offen offset:3072
    v_mul_f32 v170, s28, v160
    v_mfma_f32_16x16x32_bf16 v[80:83], a[100:103], v[152:155], v[80:83]
    s_add_u32 s32, s34, 524288
    ds_read_b64_tr_b16 v[144:145], v40 offset:59392
    v_mul_f32 v161, s28, v161
    v_mfma_f32_16x16x32_bf16 v[92:95], v[152:155], a[104:107], v[92:95]
    ds_read_b64_tr_b16 v[146:147], v40 offset:59904
    v_fma_f32 v161, -v170, v170, v161
    v_mfma_f32_16x16x32_bf16 v[72:75], a[96:99], v[156:159], v[72:75]
    v_max_f32 v161, 0, v161
    v_mfma_f32_16x16x32_bf16 v[84:87], a[100:103], v[156:159], v[84:87]
    ds_read_b64_tr_b16 v[148:149], v41 offset:27648
    v_add_f32 v161, s29, v161
    v_mfma_f32_16x16x32_bf16 v[96:99], v[156:159], a[104:107], v[96:99]
    s_waitcnt lgkmcnt(7)
    ds_read_b64_tr_b16 v[150:151], v41 offset:28160
    v_sqrt_f32 v161, v161
    v_mfma_f32_16x16x32_bf16 v[76:79], a[112:115], v[124:127], v[76:79]
    ds_read_b64_tr_b16 v[152:153], v40 offset:44032
    v_cvt_pk_bf16_f32 v162, v161, v161
    v_mfma_f32_16x16x32_bf16 v[88:91], v[124:127], a[116:119], v[88:91]
    ds_read_b64_tr_b16 v[154:155], v40 offset:44544
    v_and_b32 v161, 0xffff0000, v162
    v_mfma_f32_16x16x32_bf16 v[68:71], a[108:111], v[128:131], v[68:71]
    buffer_load_dwordx4 a[208:211], v4, s[4:7], s32 offen offset:3072
    v_rcp_f32 v168, v161
    v_mfma_f32_16x16x32_bf16 v[80:83], a[112:115], v[128:131], v[80:83]
    s_add_u32 s32, s34, 655360
    ds_read_b64_tr_b16 v[156:157], v40 offset:60416
    v_log_f32 v169, v161
    v_mfma_f32_16x16x32_bf16 v[92:95], v[128:131], a[116:119], v[92:95]
    ds_read_b64_tr_b16 v[158:159], v40 offset:60928
    v_mov_b32 v171, v168
    v_mfma_f32_16x16x32_bf16 v[72:75], a[108:111], v[132:135], v[72:75]
    ds_write_b128 v54, v[168:171]
    v_mfma_f32_16x16x32_bf16 v[84:87], a[112:115], v[132:135], v[84:87]
    ds_read_b64_tr_b16 v[124:125], v41 offset:28672
    ds_write_b16 v55, v162
    v_mfma_f32_16x16x32_bf16 v[96:99], v[132:135], a[116:119], v[96:99]
    s_waitcnt lgkmcnt(9)
    ds_read_b64_tr_b16 v[126:127], v41 offset:29184
    ds_read_b64 v[172:173], v56 offset:8
    v_mfma_f32_16x16x32_bf16 v[76:79], a[124:127], v[136:139], v[76:79]
    ds_read_b64_tr_b16 v[128:129], v40 offset:45056
    ds_read_b64 v[174:175], v56 offset:264
    v_mfma_f32_16x16x32_bf16 v[88:91], v[136:139], a[128:131], v[88:91]
    ds_read_b64_tr_b16 v[130:131], v40 offset:45568
    ds_read_b64 v[176:177], v56 offset:520
    v_mfma_f32_16x16x32_bf16 v[68:71], a[120:123], v[140:143], v[68:71]
    ds_read2_b32 v[178:179], v57 offset0:2 offset1:6
    buffer_load_dwordx4 a[212:215], v4, s[4:7], s32 offen offset:3072
    v_mfma_f32_16x16x32_bf16 v[80:83], a[124:127], v[140:143], v[80:83]
    s_add_u32 s32, s34, 786432
    ds_read_b64_tr_b16 v[132:133], v40 offset:61440
    ds_read2_b32 v[180:181], v57 offset0:10 offset1:14
    v_mfma_f32_16x16x32_bf16 v[92:95], v[140:143], a[128:131], v[92:95]
    ds_read_b64_tr_b16 v[134:135], v40 offset:61952
    ds_read2_b32 v[182:183], v57 offset0:66 offset1:70
    v_mfma_f32_16x16x32_bf16 v[72:75], a[120:123], v[144:147], v[72:75]
    ds_read2_b32 v[184:185], v57 offset0:74 offset1:78
    v_mfma_f32_16x16x32_bf16 v[84:87], a[124:127], v[144:147], v[84:87]
    ds_read_b64_tr_b16 v[136:137], v41 offset:29696
    ds_read2_b32 v[186:187], v57 offset0:130 offset1:134
    v_mfma_f32_16x16x32_bf16 v[96:99], v[144:147], a[128:131], v[96:99]
    s_waitcnt lgkmcnt(15)
    ds_read_b64_tr_b16 v[138:139], v41 offset:30208
    ds_read2_b32 v[188:189], v57 offset0:138 offset1:142
    v_mfma_f32_16x16x32_bf16 v[76:79], a[136:139], v[148:151], v[76:79]
    ds_read_b64_tr_b16 v[140:141], v40 offset:46080
    buffer_load_dwordx4 a[216:219], v4, s[4:7], s32 offen offset:3072
    v_mfma_f32_16x16x32_bf16 v[88:91], v[148:151], a[140:143], v[88:91]
    s_add_u32 s32, s34, 917504
    ds_read_b64_tr_b16 v[142:143], v40 offset:46592
    v_mfma_f32_16x16x32_bf16 v[68:71], a[132:135], v[152:155], v[68:71]
    v_mfma_f32_16x16x32_bf16 v[80:83], a[136:139], v[152:155], v[80:83]
    s_waitcnt lgkmcnt(2)
    ds_read_b64_tr_b16 v[144:145], v40 offset:62464
    v_mfma_f32_16x16x32_bf16 v[92:95], v[152:155], a[140:143], v[92:95]
    ds_read_b64_tr_b16 v[146:147], v40 offset:62976
    v_fma_f32 v76, -v24, v172, v76
    v_mfma_f32_16x16x32_bf16 v[72:75], a[132:135], v[156:159], v[72:75]
    buffer_load_dwordx4 a[220:223], v4, s[4:7], s32 offen offset:3072
    v_fma_f32 v88, -v178, v28, v88
    v_mfma_f32_16x16x32_bf16 v[84:87], a[136:139], v[156:159], v[84:87]
    s_add_u32 s32, s34, 1048576
    ds_read_b64_tr_b16 v[148:149], v41 offset:30720
    v_fma_f32 v68, -v20, v174, v68
    v_mfma_f32_16x16x32_bf16 v[96:99], v[156:159], a[140:143], v[96:99]
    ds_read_b64_tr_b16 v[150:151], v41 offset:31232
    v_fma_f32 v80, -v24, v174, v80
    v_mfma_f32_16x16x32_bf16 v[76:79], a[148:151], v[124:127], v[76:79]
    ds_read_b64_tr_b16 v[152:153], v40 offset:47104
    v_fma_f32 v92, -v182, v28, v92
    v_mfma_f32_16x16x32_bf16 v[88:91], v[124:127], a[152:155], v[88:91]
    ds_read_b64_tr_b16 v[154:155], v40 offset:47616
    v_fma_f32 v72, -v20, v176, v72
    v_mfma_f32_16x16x32_bf16 v[68:71], a[144:147], v[128:131], v[68:71]
    buffer_load_dwordx4 a[224:227], v4, s[4:7], s32 offen offset:3072
    v_fma_f32 v84, -v24, v176, v84
    v_mfma_f32_16x16x32_bf16 v[80:83], a[148:151], v[128:131], v[80:83]
    s_add_u32 s32, s34, 1179648
    ds_read_b64_tr_b16 v[156:157], v40 offset:63488
    v_fma_f32 v96, -v186, v28, v96
    v_mfma_f32_16x16x32_bf16 v[92:95], v[128:131], a[152:155], v[92:95]
    s_add_u32 s40, s74, 0
    ds_read_b64_tr_b16 v[158:159], v40 offset:64000
    v_fma_f32 v77, -v25, v172, v77
    v_mfma_f32_16x16x32_bf16 v[72:75], a[144:147], v[132:135], v[72:75]
    s_add_u32 m0, s66, 0
    ds_read_b64 v[244:245], v45 offset:32768
    v_fma_f32 v89, -v179, v28, v89
    v_mfma_f32_16x16x32_bf16 v[84:87], a[148:151], v[132:135], v[84:87]
    ds_read_b64_tr_b16 v[124:125], v41 offset:31744
    v_fma_f32 v69, -v21, v174, v69
    v_mfma_f32_16x16x32_bf16 v[96:99], v[132:135], a[152:155], v[96:99]
    s_waitcnt lgkmcnt(8)
    ds_read_b64_tr_b16 v[126:127], v41 offset:32256
    v_fma_f32 v81, -v25, v174, v81
    v_mfma_f32_16x16x32_bf16 v[76:79], a[160:163], v[136:139], v[76:79]
    ds_read_b64_tr_b16 v[128:129], v40 offset:48128
    v_fma_f32 v93, -v183, v28, v93
    v_mfma_f32_16x16x32_bf16 v[88:91], v[136:139], a[164:167], v[88:91]
    ds_read_b64_tr_b16 v[130:131], v40 offset:48640
    v_fma_f32 v73, -v21, v176, v73
    v_mfma_f32_16x16x32_bf16 v[68:71], a[156:159], v[140:143], v[68:71]
    buffer_load_dwordx4 v4, s[4:7], s40 offen offset:0 sc1 lds
    v_fma_f32 v85, -v25, v176, v85
    v_mfma_f32_16x16x32_bf16 v[80:83], a[160:163], v[140:143], v[80:83]
    ds_read_b64_tr_b16 v[132:133], v40 offset:64512
    v_fma_f32 v97, -v187, v28, v97
    v_mfma_f32_16x16x32_bf16 v[92:95], v[140:143], a[164:167], v[92:95]
    ds_read_b64_tr_b16 v[134:135], v40 offset:65024
    v_fma_f32 v78, -v26, v172, v78
    v_mfma_f32_16x16x32_bf16 v[72:75], a[156:159], v[144:147], v[72:75]
    buffer_load_dwordx4 v4, s[4:7], s40 offen offset:1024 sc1 lds
    v_fma_f32 v90, -v180, v28, v90
    v_mfma_f32_16x16x32_bf16 v[84:87], a[160:163], v[144:147], v[84:87]
    buffer_load_dwordx4 a[228:231], v4, s[4:7], s32 offen offset:3072
    v_fma_f32 v70, -v22, v174, v70
    v_mfma_f32_16x16x32_bf16 v[96:99], v[144:147], a[164:167], v[96:99]
    s_waitcnt lgkmcnt(7)
    s_add_u32 s32, s34, 1310720
    v_fma_f32 v82, -v26, v174, v82
    v_mfma_f32_16x16x32_bf16 v[76:79], a[172:175], v[148:151], v[76:79]
    buffer_load_dwordx4 v4, s[4:7], s40 offen offset:2048 sc1 lds
    v_fma_f32 v94, -v184, v28, v94
    v_mfma_f32_16x16x32_bf16 v[88:91], v[148:151], a[176:179], v[88:91]
    ds_read_b64 v[190:191], v58 offset:0
    v_fma_f32 v74, -v22, v176, v74
    v_mfma_f32_16x16x32_bf16 v[68:71], a[168:171], v[152:155], v[68:71]
    ds_read_b64 v[192:193], v59 offset:0
    v_fma_f32 v86, -v26, v176, v86
    v_mfma_f32_16x16x32_bf16 v[80:83], a[172:175], v[152:155], v[80:83]
    buffer_load_dwordx4 v4, s[4:7], s40 offen offset:3072 sc1 lds
    v_fma_f32 v98, -v188, v28, v98
    v_mfma_f32_16x16x32_bf16 v[92:95], v[152:155], a[176:179], v[92:95]
    s_add_u32 s40, s74, 16384
    s_add_u32 m0, s66, 16384
    v_fma_f32 v79, -v27, v172, v79
    v_mfma_f32_16x16x32_bf16 v[72:75], a[168:171], v[156:159], v[72:75]
    ds_read_b64 v[194:195], v58 offset:256
    v_fma_f32 v91, -v181, v28, v91
    v_mfma_f32_16x16x32_bf16 v[84:87], a[172:175], v[156:159], v[84:87]
    buffer_load_dwordx4 v4, s[4:7], s40 offen offset:0 sc1 lds
    v_fma_f32 v71, -v23, v174, v71
    v_mfma_f32_16x16x32_bf16 v[96:99], v[156:159], a[176:179], v[96:99]
    s_waitcnt lgkmcnt(3)
    ds_read_b64 v[196:197], v59 offset:256
    v_fma_f32 v83, -v27, v174, v83
    v_mfma_f32_16x16x32_bf16 v[76:79], a[184:187], v[124:127], v[76:79]
    ds_read_b64 v[198:199], v60 offset:0
    v_fma_f32 v95, -v185, v28, v95
    v_mfma_f32_16x16x32_bf16 v[88:91], v[124:127], a[188:191], v[88:91]
    buffer_load_dwordx4 v4, s[4:7], s40 offen offset:1024 sc1 lds
    v_fma_f32 v75, -v23, v176, v75
    v_mfma_f32_16x16x32_bf16 v[68:71], a[180:183], v[128:131], v[68:71]
    ds_read_b64 v[200:201], v60 offset:32
    v_fma_f32 v87, -v27, v176, v87
    v_mfma_f32_16x16x32_bf16 v[80:83], a[184:187], v[128:131], v[80:83]
    ds_read_b64 v[202:203], v60 offset:64
    v_fma_f32 v99, -v189, v28, v99
    v_mfma_f32_16x16x32_bf16 v[92:95], v[128:131], a[188:191], v[92:95]
    buffer_load_dwordx4 v4, s[4:7], s40 offen offset:2048 sc1 lds
    buffer_load_dwordx4 a[232:235], v4, s[4:7], s32 offen offset:3072
    v_mfma_f32_16x16x32_bf16 v[72:75], a[180:183], v[132:135], v[72:75]
    s_add_u32 s32, s34, 1441792
    ds_read_b64 v[246:247], v45 offset:49152
    v_mfma_f32_16x16x32_bf16 v[84:87], a[184:187], v[132:135], v[84:87]
    v_mfma_f32_16x16x32_bf16 v[96:99], v[132:135], a[188:191], v[96:99]
    buffer_load_dwordx4 v4, s[4:7], s40 offen offset:3072 sc1 lds
    v_cvt_pk_bf16_f32 v210, v76, v77
    v_cvt_pk_bf16_f32 v211, v78, v79
    v_cvt_pk_bf16_f32 v212, v80, v81
    v_cvt_pk_bf16_f32 v213, v82, v83
    v_cvt_pk_bf16_f32 v206, v68, v69
    v_cvt_pk_bf16_f32 v207, v70, v71
    v_cvt_pk_bf16_f32 v214, v84, v85
    v_cvt_pk_bf16_f32 v215, v86, v87
    v_cvt_pk_bf16_f32 v208, v72, v73
    v_cvt_pk_bf16_f32 v209, v74, v75
    v_mfma_f32_16x16x16_bf16 v[232:235], v[210:211], v[206:207], 0
    v_cvt_pk_bf16_f32 v216, v88, v89
    v_cvt_pk_bf16_f32 v217, v90, v91
    v_mfma_f32_16x16x16_bf16 v[224:227], v[212:213], v[206:207], 0
    v_cvt_pk_bf16_f32 v218, v92, v93
    v_cvt_pk_bf16_f32 v219, v94, v95
    v_mfma_f32_16x16x16_bf16 v[236:239], v[212:213], v[208:209], 0
    v_cvt_pk_bf16_f32 v220, v96, v97
    v_cvt_pk_bf16_f32 v221, v98, v99
    v_mfma_f32_16x16x16_bf16 v[228:231], v[214:215], v[208:209], 0
    v_mul_f32 v204, s30, v175
    v_mul_f32 v205, s30, v177
    s_add_u32 s41, s73, 1048576
    v_cndmask_b32 v232, v232, v233, s[54:55]
    v_cndmask_b32 v234, v234, v235, s[54:55]
    v_cndmask_b32 v224, v224, v225, s[54:55]
    v_cndmask_b32 v226, v226, v227, s[54:55]
    v_cndmask_b32 v236, v236, v237, s[54:55]
    v_cndmask_b32 v238, v238, v239, s[54:55]
    v_cndmask_b32 v228, v228, v229, s[54:55]
    v_cndmask_b32 v230, v230, v231, s[54:55]
    v_cndmask_b32 v224, v232, v224, s[56:57]
    v_cndmask_b32 v225, v234, v226, s[58:59]
    v_cndmask_b32 v228, v236, v228, s[56:57]
    v_cndmask_b32 v229, v238, v230, s[58:59]
    s_waitcnt lgkmcnt(7)
    v_mul_f32 v224, v224, v190
    s_waitcnt lgkmcnt(6)
    v_mul_f32 v225, v225, v192
    s_waitcnt lgkmcnt(5)
    v_mul_f32 v228, v228, v194
    s_waitcnt lgkmcnt(4)
    v_mul_f32 v229, v229, v196
    v_max_f32 v222, v224, v225
    v_max_f32 v223, v228, v229
    buffer_load_dwordx4 a[236:239], v4, s[4:7], s32 offen offset:3072
    s_nop 0
    v_permlane16_swap_b32 v222, v223
    v_max_f32 v222, v222, v223
    v_mov_b32 v223, v222
    s_add_u32 s32, s34, 1572864
    buffer_load_dwordx4 a[240:243], v4, s[4:7], s32 offen offset:3072
    v_permlane32_swap_b32 v222, v223
    v_max_f32 v222, v222, v223
    v_mov_b32 v223, v222
    s_add_u32 s32, s34, 1703936
    buffer_load_dwordx4 a[244:247], v4, s[4:7], s32 offen offset:3072
    v_permlane16_swap_b32 v222, v223
    v_sub_f32 v224, v224, v222
    v_sub_f32 v225, v225, v222
    v_sub_f32 v228, v228, v223
    v_sub_f32 v229, v229, v223
    v_fma_f32 v224, v224, v204, -v191
    v_fma_f32 v225, v225, v204, -v193
    v_fma_f32 v228, v228, v205, -v195
    v_fma_f32 v229, v229, v205, -v197
    v_exp_f32 v224, v224
    v_exp_f32 v225, v225
    v_exp_f32 v228, v228
    v_exp_f32 v229, v229
    v_cvt_pk_bf16_f32 v224, v224, v224
    v_cvt_pk_bf16_f32 v225, v225, v225
    v_cvt_pk_bf16_f32 v228, v228, v228
    v_cvt_pk_bf16_f32 v229, v229, v229
    v_and_b32 v232, v224, v32
    v_and_b32 v233, v225, v33
    v_and_b32 v234, v224, v34
    v_and_b32 v235, v225, v35
    v_and_b32 v236, v228, v32
    v_and_b32 v237, v229, v33
    v_and_b32 v238, v228, v34
    v_and_b32 v239, v229, v35
    s_waitcnt lgkmcnt(2)
    v_mfma_f32_16x16x32_bf16 v[160:163], v[198:201], v[232:235], 0
    s_waitcnt lgkmcnt(1)
    v_mfma_f32_16x16x32_bf16 v[164:167], v[200:203], v[236:239], 0
    v_mfma_f32_16x16x32_bf16 v[178:181], v[216:219], v[232:235], 0
    v_mfma_f32_16x16x32_bf16 v[182:185], v[218:221], v[236:239], 0
    s_add_u32 s32, s34, 1835008
    buffer_load_dwordx4 a[248:251], v4, s[4:7], s32 offen offset:3072
    s_nop 1
    v_rcp_f32 v160, v160
    s_add_u32 s32, s34, 1966080
    buffer_load_dwordx4 a[252:255], v4, s[4:7], s32 offen offset:3072
    v_rcp_f32 v164, v164
    v_mul_f32 v178, v178, v160
    v_mul_f32 v179, v179, v160
    v_mul_f32 v180, v180, v160
    v_mul_f32 v181, v181, v160
    v_mul_f32 v182, v182, v164
    v_mul_f32 v183, v183, v164
    v_mul_f32 v184, v184, v164
    v_mul_f32 v185, v185, v164
    v_cvt_pk_bf16_f32 v224, v178, v179
    v_cvt_pk_bf16_f32 v225, v180, v181
    v_cvt_pk_bf16_f32 v226, v182, v183
    v_cvt_pk_bf16_f32 v227, v184, v185
    s_nop 0
    v_permlane16_swap_b32 v224, v226
    v_permlane16_swap_b32 v225, v227
    buffer_store_dwordx4 v[224:227], v44, s[4:7], s41 offen sc1
w00_start:
    s_waitcnt vmcnt(6)
    ds_read_b32 v250, v62 offset:0
    v_lshlrev_b32 v76, 16, v240
    v_and_b32 v77, 0xffff0000, v240
    v_lshlrev_b32 v78, 16, v241
    v_and_b32 v79, 0xffff0000, v241
    v_lshlrev_b32 v80, 16, v242
    v_and_b32 v81, 0xffff0000, v242
    v_lshlrev_b32 v82, 16, v243
    v_and_b32 v83, 0xffff0000, v243
    s_waitcnt lgkmcnt(0)
    v_cmp_eq_u32 vcc, -1, v250
    s_cbranch_vccnz ps3
pe3:
    s_barrier
    ds_read_b128 v[132:135], v4 offset:0
    ds_read_b128 v[136:139], v4 offset:1024
    ds_read_b128 v[140:143], v4 offset:2048
    ds_read_b128 v[144:147], v4 offset:3072
    ds_read_b128 v[148:151], v4 offset:16384
    ds_read_b128 v[152:155], v4 offset:17408
    s_waitcnt lgkmcnt(5)
    v_mfma_f32_16x16x32_bf16 v[68:71], v[132:135], a[192:195], v[76:79]
    s_mov_b32 s41, 4194304
    s_add_u32 s42, s33, 14712832
    ds_read_b128 v[156:159], v4 offset:18432
    s_waitcnt lgkmcnt(5)
    v_mfma_f32_16x16x32_bf16 v[68:71], v[136:139], a[196:199], v[68:71]
    s_waitcnt lgkmcnt(3)
    ds_read_b128 v[160:163], v4 offset:19456
    v_mfma_f32_16x16x32_bf16 v[68:71], v[140:143], a[200:203], v[68:71]
    ds_read_b128 v[164:167], v4 offset:4096
    v_mfma_f32_16x16x32_bf16 v[68:71], v[144:147], a[204:207], v[68:71]
    s_waitcnt lgkmcnt(3)
    ds_read_b128 v[168:171], v4 offset:5120
    v_mfma_f32_16x16x32_bf16 v[72:75], v[148:151], a[192:195], v[80:83]
    ds_read_b128 v[172:175], v4 offset:6144
    v_mfma_f32_16x16x32_bf16 v[72:75], v[152:155], a[196:199], v[72:75]
    s_waitcnt lgkmcnt(3)
    ds_read_b128 v[176:179], v4 offset:7168
    v_mfma_f32_16x16x32_bf16 v[72:75], v[156:159], a[200:203], v[72:75]
    ds_read_b128 v[180:183], v4 offset:20480
    v_mfma_f32_16x16x32_bf16 v[72:75], v[160:163], a[204:207], v[72:75]
    s_waitcnt lgkmcnt(3)
    ds_read_b128 v[184:187], v4 offset:21504
    v_mfma_f32_16x16x32_bf16 v[68:71], v[164:167], a[208:211], v[68:71]
    ds_read_b128 v[188:191], v4 offset:22528
    v_mfma_f32_16x16x32_bf16 v[68:71], v[168:171], a[212:215], v[68:71]
    s_waitcnt lgkmcnt(3)
    ds_read_b128 v[192:195], v4 offset:23552
    v_mfma_f32_16x16x32_bf16 v[68:71], v[172:175], a[216:219], v[68:71]
    ds_read_b128 v[132:135], v4 offset:8192
    v_mfma_f32_16x16x32_bf16 v[68:71], v[176:179], a[220:223], v[68:71]
    s_waitcnt lgkmcnt(3)
    ds_read_b128 v[136:139], v4 offset:9216
    v_mfma_f32_16x16x32_bf16 v[72:75], v[180:183], a[208:211], v[72:75]
    ds_read_b128 v[140:143], v4 offset:10240
    v_mfma_f32_16x16x32_bf16 v[72:75], v[184:187], a[212:215], v[72:75]
    s_waitcnt lgkmcnt(3)
    ds_read_b128 v[144:147], v4 offset:11264
    v_mfma_f32_16x16x32_bf16 v[72:75], v[188:191], a[216:219], v[72:75]
    ds_read_b128 v[148:151], v4 offset:24576
    v_mfma_f32_16x16x32_bf16 v[72:75], v[192:195], a[220:223], v[72:75]
    s_waitcnt lgkmcnt(3)
    ds_read_b128 v[152:155], v4 offset:25600
    v_mfma_f32_16x16x32_bf16 v[68:71], v[132:135], a[224:227], v[68:71]
    ds_read_b128 v[156:159], v4 offset:26624
    v_mfma_f32_16x16x32_bf16 v[68:71], v[136:139], a[228:231], v[68:71]
    s_waitcnt lgkmcnt(3)
    ds_read_b128 v[160:163], v4 offset:27648
    v_mfma_f32_16x16x32_bf16 v[68:71], v[140:143], a[232:235], v[68:71]
    ds_read_b128 v[164:167], v4 offset:12288
    s_waitcnt vmcnt(5)
    v_mfma_f32_16x16x32_bf16 v[68:71], v[144:147], a[236:239], v[68:71]
    s_waitcnt lgkmcnt(3)
    ds_read_b128 v[168:171], v4 offset:13312
    v_mfma_f32_16x16x32_bf16 v[72:75], v[148:151], a[224:227], v[72:75]
    ds_read_b128 v[172:175], v4 offset:14336
    v_mfma_f32_16x16x32_bf16 v[72:75], v[152:155], a[228:231], v[72:75]
    s_waitcnt lgkmcnt(3)
    ds_read_b128 v[176:179], v4 offset:15360
    v_mfma_f32_16x16x32_bf16 v[72:75], v[156:159], a[232:235], v[72:75]
    ds_read_b128 v[180:183], v4 offset:28672
    v_mfma_f32_16x16x32_bf16 v[72:75], v[160:163], a[236:239], v[72:75]
    s_waitcnt lgkmcnt(3)
    ds_read_b128 v[184:187], v4 offset:29696
    s_waitcnt vmcnt(4)
    v_mfma_f32_16x16x32_bf16 v[68:71], v[164:167], a[240:243], v[68:71]
    ds_read_b128 v[188:191], v4 offset:30720
    s_waitcnt vmcnt(3)
    v_mfma_f32_16x16x32_bf16 v[68:71], v[168:171], a[244:247], v[68:71]
    s_waitcnt lgkmcnt(3)
    ds_read_b128 v[192:195], v4 offset:31744
    s_waitcnt vmcnt(2)
    v_mfma_f32_16x16x32_bf16 v[68:71], v[172:175], a[248:251], v[68:71]
    s_waitcnt vmcnt(1)
    v_mfma_f32_16x16x32_bf16 v[68:71], v[176:179], a[252:255], v[68:71]
    s_waitcnt lgkmcnt(2)
    v_mfma_f32_16x16x32_bf16 v[72:75], v[180:183], a[240:243], v[72:75]
    v_mfma_f32_16x16x32_bf16 v[72:75], v[184:187], a[244:247], v[72:75]
    s_waitcnt lgkmcnt(0)
    v_mfma_f32_16x16x32_bf16 v[72:75], v[188:191], a[248:251], v[72:75]
    v_mfma_f32_16x16x32_bf16 v[72:75], v[192:195], a[252:255], v[72:75]
    s_nop 1
    v_cmp_u_f32 s[18:19], v68, v69
    v_cmp_u_f32 s[20:21], v70, v71
    s_nop 3
    v_cmp_u_f32 s[22:23], v72, v73
    v_cmp_u_f32 vcc, v74, v75
    v_cvt_pk_bf16_f32 v116, v68, v69
    v_cvt_pk_bf16_f32 v117, v70, v71
    v_cvt_pk_bf16_f32 v118, v72, v73
    v_cvt_pk_bf16_f32 v119, v74, v75
    s_or_b64 s[18:19], s[18:19], s[20:21]
    s_or_b64 vcc, vcc, s[22:23]
    s_or_b64 vcc, vcc, s[18:19]
    s_cbranch_vccnz rt4
rc4:
    ds_write_b64 v47, v[116:117] offset:0
    ds_write_b64 v47, v[118:119] offset:2048
    ds_read_b128 v[120:123], v48 offset:0
    s_add_u32 s40, s74, 1048576
    s_add_u32 m0, s66, 32768
    s_nop 0
    buffer_load_dwordx4 v4, s[4:7], s40 offen offset:0 sc1 lds
    buffer_load_dwordx4 v4, s[4:7], s40 offen offset:1024 sc1 lds
    buffer_load_dwordx4 v4, s[4:7], s40 offen offset:2048 sc1 lds
    buffer_load_dwordx4 v4, s[4:7], s40 offen offset:3072 sc1 lds
    s_waitcnt lgkmcnt(1)
    s_barrier
    ds_read_b64_tr_b16 v[84:85], v49 offset:0
    ds_read_b64_tr_b16 v[86:87], v49 offset:512
    ds_read_b64_tr_b16 v[88:89], v49 offset:1024
    ds_read_b64_tr_b16 v[90:91], v49 offset:1536
    s_waitcnt lgkmcnt(4)
    buffer_store_dwordx4 v[120:123], v50, s[4:7], s41 offen sc1
    s_waitcnt lgkmcnt(2)
    v_mfma_f32_16x16x32_bf16 v[92:95], v[84:87], v[84:87], 0
    s_waitcnt lgkmcnt(0)
    v_mfma_f32_16x16x32_bf16 v[92:95], v[88:91], v[88:91], v[92:95]
    v_mfma_f32_16x16x32_bf16 v[96:99], v[16:19], v[84:87], 0
    v_mfma_f32_16x16x32_bf16 v[96:99], v[16:19], v[88:91], v[96:99]
    s_add_u32 s40, s74, 1064960
    s_add_u32 m0, s66, 49152
    s_nop 0
    buffer_load_dwordx4 v4, s[4:7], s40 offen offset:0 sc1 lds
    buffer_load_dwordx4 v4, s[4:7], s40 offen offset:1024 sc1 lds
    buffer_load_dwordx4 v4, s[4:7], s40 offen offset:2048 sc1 lds
    buffer_load_dwordx4 v4, s[4:7], s40 offen offset:3072 sc1 lds
    v_cndmask_b32 v92, v92, v93, s[48:49]
    v_cndmask_b32 v92, v92, v94, s[50:51]
    v_cndmask_b32 v92, v92, v95, s[52:53]
    v_cndmask_b32 v92, v96, v92, s[70:71]
    ds_bpermute_b32 v92, v67, v92
    s_waitcnt lgkmcnt(0)
    v_cndmask_b32 v92, v92, 1.0, s[50:51]
    v_cndmask_b32 v92, v92, 0, s[52:53]
    buffer_atomic_add_f32 v92, v64, s[4:7], s42 offen sc1
w10_start:
    s_waitcnt vmcnt(1)
    ds_read_b32 v250, v62 offset:32768
    v_lshlrev_b32 v76, 16, v244
    v_and_b32 v77, 0xffff0000, v244
    v_lshlrev_b32 v78, 16, v245
    v_and_b32 v79, 0xffff0000, v245
    v_lshlrev_b32 v80, 16, v246
    v_and_b32 v81, 0xffff0000, v246
    v_lshlrev_b32 v82, 16, v247
    v_and_b32 v83, 0xffff0000, v247
    s_waitcnt lgkmcnt(0)
    v_cmp_eq_u32 vcc, -1, v250
    s_cbranch_vccnz ps5
pe5:
    s_barrier
    ds_read_b128 v[132:135], v4 offset:32768
    ds_read_b128 v[136:139], v4 offset:33792
    ds_read_b128 v[140:143], v4 offset:34816
    ds_read_b128 v[144:147], v4 offset:35840
    ds_read_b128 v[148:151], v4 offset:49152
    ds_read_b128 v[152:155], v4 offset:50176
    s_waitcnt lgkmcnt(5)
    v_mfma_f32_16x16x32_bf16 v[68:71], v[132:135], a[192:195], v[76:79]
    s_mov_b32 s41, 5242880
    s_add_u32 s42, s33, 14729216
    ds_read_b128 v[156:159], v4 offset:51200
    s_waitcnt lgkmcnt(5)
    v_mfma_f32_16x16x32_bf16 v[68:71], v[136:139], a[196:199], v[68:71]
    s_waitcnt lgkmcnt(3)
    ds_read_b128 v[160:163], v4 offset:52224
    v_mfma_f32_16x16x32_bf16 v[68:71], v[140:143], a[200:203], v[68:71]
    ds_read_b128 v[164:167], v4 offset:36864
    v_mfma_f32_16x16x32_bf16 v[68:71], v[144:147], a[204:207], v[68:71]
    s_waitcnt lgkmcnt(3)
    ds_read_b128 v[168:171], v4 offset:37888
    v_mfma_f32_16x16x32_bf16 v[72:75], v[148:151], a[192:195], v[80:83]
    ds_read_b128 v[172:175], v4 offset:38912
    v_mfma_f32_16x16x32_bf16 v[72:75], v[152:155], a[196:199], v[72:75]
    s_waitcnt lgkmcnt(3)
    ds_read_b128 v[176:179], v4 offset:39936
    v_mfma_f32_16x16x32_bf16 v[72:75], v[156:159], a[200:203], v[72:75]
    ds_read_b128 v[180:183], v4 offset:53248
    v_mfma_f32_16x16x32_bf16 v[72:75], v[160:163], a[204:207], v[72:75]
    s_waitcnt lgkmcnt(3)
    ds_read_b128 v[184:187], v4 offset:54272
    v_mfma_f32_16x16x32_bf16 v[68:71], v[164:167], a[208:211], v[68:71]
    ds_read_b128 v[188:191], v4 offset:55296
    v_mfma_f32_16x16x32_bf16 v[68:71], v[168:171], a[212:215], v[68:71]
    s_waitcnt lgkmcnt(3)
    ds_read_b128 v[192:195], v4 offset:56320
    v_mfma_f32_16x16x32_bf16 v[68:71], v[172:175], a[216:219], v[68:71]
    ds_read_b128 v[132:135], v4 offset:40960
    v_mfma_f32_16x16x32_bf16 v[68:71], v[176:179], a[220:223], v[68:71]
    s_waitcnt lgkmcnt(3)
    ds_read_b128 v[136:139], v4 offset:41984
    v_mfma_f32_16x16x32_bf16 v[72:75], v[180:183], a[208:211], v[72:75]
    ds_read_b128 v[140:143], v4 offset:43008
    v_mfma_f32_16x16x32_bf16 v[72:75], v[184:187], a[212:215], v[72:75]
    s_waitcnt lgkmcnt(3)
    ds_read_b128 v[144:147], v4 offset:44032
    v_mfma_f32_16x16x32_bf16 v[72:75], v[188:191], a[216:219], v[72:75]
    ds_read_b128 v[148:151], v4 offset:57344
    v_mfma_f32_16x16x32_bf16 v[72:75], v[192:195], a[220:223], v[72:75]
    s_waitcnt lgkmcnt(3)
    ds_read_b128 v[152:155], v4 offset:58368
    v_mfma_f32_16x16x32_bf16 v[68:71], v[132:135], a[224:227], v[68:71]
    ds_read_b128 v[156:159], v4 offset:59392
    v_mfma_f32_16x16x32_bf16 v[68:71], v[136:139], a[228:231], v[68:71]
    s_waitcnt lgkmcnt(3)
    ds_read_b128 v[160:163], v4 offset:60416
    v_mfma_f32_16x16x32_bf16 v[68:71], v[140:143], a[232:235], v[68:71]
    ds_read_b128 v[164:167], v4 offset:45056
    v_mfma_f32_16x16x32_bf16 v[68:71], v[144:147], a[236:239], v[68:71]
    s_waitcnt lgkmcnt(3)
    ds_read_b128 v[168:171], v4 offset:46080
    v_mfma_f32_16x16x32_bf16 v[72:75], v[148:151], a[224:227], v[72:75]
    ds_read_b128 v[172:175], v4 offset:47104
    v_mfma_f32_16x16x32_bf16 v[72:75], v[152:155], a[228:231], v[72:75]
    s_waitcnt lgkmcnt(3)
    ds_read_b128 v[176:179], v4 offset:48128
    v_mfma_f32_16x16x32_bf16 v[72:75], v[156:159], a[232:235], v[72:75]
    ds_read_b128 v[180:183], v4 offset:61440
    v_mfma_f32_16x16x32_bf16 v[72:75], v[160:163], a[236:239], v[72:75]
    s_waitcnt lgkmcnt(3)
    ds_read_b128 v[184:187], v4 offset:62464
    v_mfma_f32_16x16x32_bf16 v[68:71], v[164:167], a[240:243], v[68:71]
    ds_read_b128 v[188:191], v4 offset:63488
    v_mfma_f32_16x16x32_bf16 v[68:71], v[168:171], a[244:247], v[68:71]
iw4:
    s_cbranch_execz iw8
    s_waitcnt lgkmcnt(3)
    ds_read_b128 v[192:195], v4 offset:64512
    v_mfma_f32_16x16x32_bf16 v[68:71], v[172:175], a[248:251], v[68:71]
    v_mfma_f32_16x16x32_bf16 v[68:71], v[176:179], a[252:255], v[68:71]
    s_waitcnt lgkmcnt(2)
    v_mfma_f32_16x16x32_bf16 v[72:75], v[180:183], a[240:243], v[72:75]
    v_mfma_f32_16x16x32_bf16 v[72:75], v[184:187], a[244:247], v[72:75]
    s_waitcnt lgkmcnt(0)
    v_mfma_f32_16x16x32_bf16 v[72:75], v[188:191], a[248:251], v[72:75]
    v_mfma_f32_16x16x32_bf16 v[72:75], v[192:195], a[252:255], v[72:75]
    s_nop 1
    v_cmp_u_f32 s[18:19], v68, v69
    v_cmp_u_f32 s[20:21], v70, v71
    s_nop 3
    v_cmp_u_f32 s[22:23], v72, v73
    v_cmp_u_f32 vcc, v74, v75
    v_cvt_pk_bf16_f32 v116, v68, v69
    v_cvt_pk_bf16_f32 v117, v70, v71
    v_cvt_pk_bf16_f32 v118, v72, v73
    v_cvt_pk_bf16_f32 v119, v74, v75
    s_or_b64 s[18:19], s[18:19], s[20:21]
    s_or_b64 vcc, vcc, s[22:23]
    s_or_b64 vcc, vcc, s[18:19]
    s_cbranch_vccnz rt6
rc6:
    ds_write_b64 v47, v[116:117] offset:4096
    ds_write_b64 v47, v[118:119] offset:6144
    ds_read_b128 v[120:123], v48 offset:4096
    s_waitcnt lgkmcnt(1)
    s_barrier
    ds_read_b64_tr_b16 v[84:85], v49 offset:4096
    ds_read_b64_tr_b16 v[86:87], v49 offset:4608
    ds_read_b64_tr_b16 v[88:89], v49 offset:5120
    ds_read_b64_tr_b16 v[90:91], v49 offset:5632
    s_waitcnt lgkmcnt(4)
    buffer_store_dwordx4 v[120:123], v50, s[4:7], s41 offen sc1
    s_waitcnt lgkmcnt(2)
    v_mfma_f32_16x16x32_bf16 v[92:95], v[84:87], v[84:87], 0
    s_waitcnt lgkmcnt(0)
    v_mfma_f32_16x16x32_bf16 v[92:95], v[88:91], v[88:91], v[92:95]
    v_mfma_f32_16x16x32_bf16 v[96:99], v[16:19], v[84:87], 0
    v_mfma_f32_16x16x32_bf16 v[96:99], v[16:19], v[88:91], v[96:99]
    s_nop 5
    v_cndmask_b32 v92, v92, v93, s[48:49]
    v_cndmask_b32 v92, v92, v94, s[50:51]
    v_cndmask_b32 v92, v92, v95, s[52:53]
    v_cndmask_b32 v92, v96, v92, s[70:71]
    ds_bpermute_b32 v92, v67, v92
    s_mov_b32 s18, 14712832
    s_add_u32 s23, s75, 4194304
    buffer_load_dwordx4 v[216:219], v6, s[4:7], s18 offen offset:0 sc1
    buffer_load_dwordx4 v[220:223], v6, s[4:7], s18 offen offset:1024 sc1
    buffer_load_dwordx4 v[224:227], v6, s[4:7], s18 offen offset:2048 sc1
    buffer_load_dwordx4 v[228:231], v6, s[4:7], s18 offen offset:3072 sc1
    buffer_load_dwordx4 v[212:215], v5, s[4:7], s23 offen sc1
    s_waitcnt lgkmcnt(0)
    v_cndmask_b32 v92, v92, 1.0, s[50:51]
    v_cndmask_b32 v92, v92, 0, s[52:53]
    buffer_atomic_add_f32 v92, v64, s[4:7], s42 offen sc1
    v_mov_b32 v254, s29
    s_mov_b32 s16, 1
    s_add_u32 s64, s64, 4194304
    s_add_u32 s73, s73, 2097152
    s_add_u32 s74, s74, 2097152
    ds_read2_b32 v[68:69], v8 offset0:0 offset1:1
    ds_read2_b32 v[70:71], v8 offset0:2 offset1:3
    ds_read2_b32 v[72:73], v8 offset0:128 offset1:129
    ds_read2_b32 v[74:75], v8 offset0:130 offset1:131
    ds_read2_b32 v[76:77], v9 offset0:0 offset1:1
    ds_read2_b32 v[78:79], v9 offset0:2 offset1:3
    ds_read2_b32 v[80:81], v9 offset0:128 offset1:129
    ds_read2_b32 v[82:83], v9 offset0:130 offset1:131
    ds_read2_b32 v[84:85], v8 offset0:16 offset1:17
    ds_read2_b32 v[86:87], v8 offset0:18 offset1:19
    ds_read2_b32 v[88:89], v8 offset0:144 offset1:145
    ds_read2_b32 v[90:91], v8 offset0:146 offset1:147
    ds_read2_b32 v[92:93], v9 offset0:16 offset1:17
    ds_read2_b32 v[94:95], v9 offset0:18 offset1:19
    ds_read2_b32 v[96:97], v9 offset0:144 offset1:145
    ds_read2_b32 v[98:99], v9 offset0:146 offset1:147
    ds_read2_b32 v[100:101], v8 offset0:32 offset1:33
    ds_read2_b32 v[102:103], v8 offset0:34 offset1:35
    ds_read2_b32 v[104:105], v8 offset0:160 offset1:161
    ds_read2_b32 v[106:107], v8 offset0:162 offset1:163
    ds_read2_b32 v[108:109], v9 offset0:32 offset1:33
    ds_read2_b32 v[110:111], v9 offset0:34 offset1:35
    ds_read2_b32 v[112:113], v9 offset0:160 offset1:161
    ds_read2_b32 v[114:115], v9 offset0:162 offset1:163
    ds_read2_b32 v[116:117], v8 offset0:48 offset1:49
    ds_read2_b32 v[118:119], v8 offset0:50 offset1:51
    ds_read2_b32 v[120:121], v8 offset0:176 offset1:177
    ds_read2_b32 v[122:123], v8 offset0:178 offset1:179
    ds_read2_b32 v[124:125], v9 offset0:48 offset1:49
    ds_read2_b32 v[126:127], v9 offset0:50 offset1:51
    ds_read2_b32 v[128:129], v9 offset0:176 offset1:177
    ds_read2_b32 v[130:131], v9 offset0:178 offset1:179
    s_waitcnt vmcnt(1)
    v_min3_f32 v218, v218, v222, v226
    v_max3_u32 v222, v212, v213, v214
    v_min_f32 v218, v218, v230
    v_max_u32 v222, v222, v215
    v_cmp_gt_f32 vcc, 0x41000000, v218
    v_cmp_eq_u32 s[20:21], -1, v222
    s_nop 3
    s_or_b64 vcc, vcc, s[20:21]
    s_cbranch_vccnz ps7
pe7:
    v_mul_f32 v216, s28, v216
    v_mul_f32 v220, s28, v220
    v_mul_f32 v224, s28, v224
    v_mul_f32 v228, s28, v228
    v_fma_f32 v217, v217, s28, v254
    v_fma_f32 v221, v221, s28, v254
    v_fma_f32 v225, v225, s28, v254
    v_fma_f32 v229, v229, s28, v254
    v_fma_f32 v217, -v216, v216, v217
    v_fma_f32 v221, -v220, v220, v221
    v_fma_f32 v225, -v224, v224, v225
    v_fma_f32 v229, -v228, v228, v229
    v_max_f32 v217, s29, v217
    v_max_f32 v221, s29, v221
    v_max_f32 v225, s29, v225
    v_max_f32 v229, s29, v229
    v_rsq_f32 v217, v217
    v_rsq_f32 v221, v221
    v_rsq_f32 v225, v225
    v_rsq_f32 v229, v229
    v_lshlrev_b32 v232, 16, v212
    v_and_b32 v233, 0xffff0000, v212
    v_lshlrev_b32 v234, 16, v213
    v_and_b32 v235, 0xffff0000, v213
    v_lshlrev_b32 v236, 16, v214
    v_and_b32 v237, 0xffff0000, v214
    v_lshlrev_b32 v238, 16, v215
    v_and_b32 v239, 0xffff0000, v215
    v_subrev_f32_dpp v240, v216, v232 quad_perm:[0,1,0,1] row_mask:0xf bank_mask:0xf
    v_subrev_f32_dpp v241, v220, v233 quad_perm:[0,1,0,1] row_mask:0xf bank_mask:0xf
    v_subrev_f32_dpp v242, v224, v234 quad_perm:[0,1,0,1] row_mask:0xf bank_mask:0xf
    v_subrev_f32_dpp v243, v228, v235 quad_perm:[0,1,0,1] row_mask:0xf bank_mask:0xf
    v_subrev_f32_dpp v244, v216, v236 quad_perm:[2,3,2,3] row_mask:0xf bank_mask:0xf
    v_subrev_f32_dpp v245, v220, v237 quad_perm:[2,3,2,3] row_mask:0xf bank_mask:0xf
    v_subrev_f32_dpp v246, v224, v238 quad_perm:[2,3,2,3] row_mask:0xf bank_mask:0xf
    v_subrev_f32_dpp v247, v228, v239 quad_perm:[2,3,2,3] row_mask:0xf bank_mask:0xf
    v_mul_f32_dpp v240, v217, v240 quad_perm:[0,1,0,1] row_mask:0xf bank_mask:0xf
    v_mul_f32_dpp v241, v221, v241 quad_perm:[0,1,0,1] row_mask:0xf bank_mask:0xf
    v_mul_f32_dpp v242, v225, v242 quad_perm:[0,1,0,1] row_mask:0xf bank_mask:0xf
    v_mul_f32_dpp v243, v229, v243 quad_perm:[0,1,0,1] row_mask:0xf bank_mask:0xf
    v_mul_f32_dpp v244, v217, v244 quad_perm:[2,3,2,3] row_mask:0xf bank_mask:0xf
    v_mul_f32_dpp v245, v221, v245 quad_perm:[2,3,2,3] row_mask:0xf bank_mask:0xf
    v_mul_f32_dpp v246, v225, v246 quad_perm:[2,3,2,3] row_mask:0xf bank_mask:0xf
    v_mul_f32_dpp v247, v229, v247 quad_perm:[2,3,2,3] row_mask:0xf bank_mask:0xf
    v_cvt_pk_bf16_f32 v212, v247, v246
    v_cvt_pk_bf16_f32 v213, v245, v244
    v_cvt_pk_bf16_f32 v214, v243, v242
    v_cvt_pk_bf16_f32 v215, v241, v240
    ds_write_b128 v15, v[212:215] offset:2048
    s_waitcnt lgkmcnt(0)
    s_barrier
    ds_read_b128 v[132:135], v7 offset:3584
    ds_read_b128 v[136:139], v7 offset:3072
    ds_read_b128 v[140:143], v7 offset:2560
    ds_read_b128 v[144:147], v7 offset:2048
    ds_read_b128 v[148:151], v7 offset:3648
    ds_read_b128 v[152:155], v7 offset:3136
    ds_read_b128 v[156:159], v7 offset:2624
    ds_read_b128 v[160:163], v7 offset:2112
    s_waitcnt lgkmcnt(7)
    v_mfma_f32_16x16x32_bf16 v[180:183], v[68:71], v[132:135], 0
    v_fmac_f32 v232, v66, v240
    v_mov_b32 v248, -1
    v_mfma_f32_16x16x32_bf16 v[184:187], v[72:75], v[132:135], 0
    v_fmac_f32 v233, v66, v241
    v_mov_b32 v249, -1
    s_waitcnt lgkmcnt(6)
    v_mfma_f32_16x16x32_bf16 v[184:187], v[68:71], v[136:139], v[184:187]
    v_fmac_f32 v234, v66, v242
    v_mov_b32 v250, -1
    v_mfma_f32_16x16x32_bf16 v[188:191], v[76:79], v[132:135], 0
    v_fmac_f32 v235, v66, v243
    v_mov_b32 v251, -1
    v_mfma_f32_16x16x32_bf16 v[188:191], v[72:75], v[136:139], v[188:191]
    v_fmac_f32 v236, v66, v244
    s_waitcnt lgkmcnt(5)
    v_mfma_f32_16x16x32_bf16 v[188:191], v[68:71], v[140:143], v[188:191]
    v_fmac_f32 v237, v66, v245
    v_mfma_f32_16x16x32_bf16 v[192:195], v[80:83], v[132:135], 0
    v_fmac_f32 v238, v66, v246
    v_mfma_f32_16x16x32_bf16 v[192:195], v[76:79], v[136:139], v[192:195]
    v_fmac_f32 v239, v66, v247
    v_mfma_f32_16x16x32_bf16 v[192:195], v[72:75], v[140:143], v[192:195]
    s_waitcnt lgkmcnt(4)
    v_mfma_f32_16x16x32_bf16 v[192:195], v[68:71], v[144:147], v[192:195]
    s_waitcnt lgkmcnt(0)
    v_mfma_f32_16x16x32_bf16 v[192:195], v[84:87], v[160:163], v[192:195]
    ds_read_b128 v[132:135], v7 offset:3712
    v_mfma_f32_16x16x32_bf16 v[192:195], v[88:91], v[156:159], v[192:195]
    ds_read_b128 v[136:139], v7 offset:3200
    v_mfma_f32_16x16x32_bf16 v[192:195], v[92:95], v[152:155], v[192:195]
    ds_read_b128 v[140:143], v7 offset:2688
    v_mfma_f32_16x16x32_bf16 v[192:195], v[96:99], v[148:151], v[192:195]
    ds_read_b128 v[144:147], v7 offset:2176
    v_mfma_f32_16x16x32_bf16 v[188:191], v[84:87], v[156:159], v[188:191]
    v_mfma_f32_16x16x32_bf16 v[188:191], v[88:91], v[152:155], v[188:191]
    v_mfma_f32_16x16x32_bf16 v[188:191], v[92:95], v[148:151], v[188:191]
    v_mfma_f32_16x16x32_bf16 v[184:187], v[84:87], v[152:155], v[184:187]
    v_mfma_f32_16x16x32_bf16 v[184:187], v[88:91], v[148:151], v[184:187]
    v_mfma_f32_16x16x32_bf16 v[180:183], v[84:87], v[148:151], v[180:183]
    s_waitcnt lgkmcnt(0)
    v_mfma_f32_16x16x32_bf16 v[192:195], v[100:103], v[144:147], v[192:195]
    ds_read_b128 v[148:151], v7 offset:3776
    v_mfma_f32_16x16x32_bf16 v[192:195], v[104:107], v[140:143], v[192:195]
    ds_read_b128 v[152:155], v7 offset:3264
    v_mfma_f32_16x16x32_bf16 v[192:195], v[108:111], v[136:139], v[192:195]
    ds_read_b128 v[156:159], v7 offset:2752
    v_mfma_f32_16x16x32_bf16 v[192:195], v[112:115], v[132:135], v[192:195]
    ds_read_b128 v[160:163], v7 offset:2240
    v_mfma_f32_16x16x32_bf16 v[188:191], v[100:103], v[140:143], v[188:191]
    v_mfma_f32_16x16x32_bf16 v[188:191], v[104:107], v[136:139], v[188:191]
    v_mfma_f32_16x16x32_bf16 v[188:191], v[108:111], v[132:135], v[188:191]
    v_mfma_f32_16x16x32_bf16 v[184:187], v[100:103], v[136:139], v[184:187]
    v_mfma_f32_16x16x32_bf16 v[184:187], v[104:107], v[132:135], v[184:187]
    v_mfma_f32_16x16x32_bf16 v[180:183], v[100:103], v[132:135], v[180:183]
    s_waitcnt lgkmcnt(0)
    v_mfma_f32_16x16x32_bf16 v[180:183], v[116:119], v[148:151], v[180:183]
    ds_read_b128 v[144:147], v7 offset:2048
    v_mfma_f32_16x16x32_bf16 v[184:187], v[120:123], v[148:151], v[184:187]
    ds_read_b128 v[140:143], v7 offset:2560
    v_mfma_f32_16x16x32_bf16 v[184:187], v[116:119], v[152:155], v[184:187]
    ds_read_b128 v[136:139], v7 offset:3072
    v_mfma_f32_16x16x32_bf16 v[188:191], v[124:127], v[148:151], v[188:191]
    ds_read_b128 v[132:135], v7 offset:3584
    v_mfma_f32_16x16x32_bf16 v[188:191], v[120:123], v[152:155], v[188:191]
    s_mov_b32 s18, 14729216
    ds_write_b128 v12, v[180:183] offset:0
    v_mfma_f32_16x16x32_bf16 v[188:191], v[116:119], v[156:159], v[188:191]
    s_add_u32 s23, s75, 5242880
    buffer_load_dwordx4 v[216:219], v6, s[4:7], s18 offen offset:0 sc1
    v_mfma_f32_16x16x32_bf16 v[192:195], v[128:131], v[148:151], v[192:195]
    buffer_load_dwordx4 v[220:223], v6, s[4:7], s18 offen offset:1024 sc1
    v_mfma_f32_16x16x32_bf16 v[192:195], v[124:127], v[152:155], v[192:195]
    ds_write_b128 v12, v[184:187] offset:1024
    v_mfma_f32_16x16x32_bf16 v[192:195], v[120:123], v[156:159], v[192:195]
    buffer_load_dwordx4 v[224:227], v6, s[4:7], s18 offen offset:2048 sc1
    v_mfma_f32_16x16x32_bf16 v[192:195], v[116:119], v[160:163], v[192:195]
    ds_write_b128 v12, v[188:191] offset:2048
    buffer_load_dwordx4 v[228:231], v6, s[4:7], s18 offen offset:3072 sc1
    buffer_load_dwordx4 v[212:215], v5, s[4:7], s23 offen sc1
    s_nop 4
    ds_write_b128 v12, v[192:195] offset:3072
    s_add_u32 s22, s75, 6291456
    s_waitcnt lgkmcnt(0)
    s_barrier
    ds_read_b128 v[164:167], v13 offset:0
    ds_read_b128 v[168:171], v14 offset:0
    ds_read_b128 v[172:175], v13 offset:4096
    ds_read_b128 v[176:179], v14 offset:4096
    s_waitcnt lgkmcnt(3)
    v_add_f32 v232, v232, v164
    v_add_f32 v233, v233, v165
    v_add_f32 v234, v234, v166
    v_add_f32 v235, v235, v167
    s_waitcnt lgkmcnt(2)
    v_add_f32 v236, v236, v168
    v_add_f32 v237, v237, v169
    v_add_f32 v238, v238, v170
    v_add_f32 v239, v239, v171
    s_waitcnt lgkmcnt(1)
    v_add_f32 v232, v232, v172
    v_add_f32 v233, v233, v173
    v_add_f32 v234, v234, v174
    v_add_f32 v235, v235, v175
    s_waitcnt lgkmcnt(0)
    v_add_f32 v236, v236, v176
    v_add_f32 v237, v237, v177
    v_add_f32 v238, v238, v178
    v_add_f32 v239, v239, v179
    v_cvt_pk_bf16_f32 v240, v232, v233
    v_cvt_pk_bf16_f32 v241, v234, v235
    v_cvt_pk_bf16_f32 v242, v236, v237
    v_cvt_pk_bf16_f32 v243, v238, v239
    buffer_store_dwordx4 v[240:243], v5, s[4:7], s22 offen sc1
    ds_read2_b32 v[164:165], v10 offset0:0 offset1:1
    ds_read2_b32 v[166:167], v10 offset0:2 offset1:3
    ds_read2_b32 v[168:169], v10 offset0:128 offset1:129
    ds_read2_b32 v[170:171], v10 offset0:130 offset1:131
    ds_read2_b32 v[172:173], v11 offset0:0 offset1:1
    ds_read2_b32 v[174:175], v11 offset0:2 offset1:3
    ds_read2_b32 v[176:177], v11 offset0:128 offset1:129
    ds_read2_b32 v[178:179], v11 offset0:130 offset1:131
    v_mfma_f32_16x16x32_bf16 v[196:199], v[72:75], v[144:147], 0
    ds_read_b128 v[160:163], v7 offset:2112
    v_mfma_f32_16x16x32_bf16 v[200:203], v[76:79], v[144:147], 0
    ds_read_b128 v[156:159], v7 offset:2624
    v_mfma_f32_16x16x32_bf16 v[196:199], v[76:79], v[140:143], v[196:199]
    ds_read_b128 v[152:155], v7 offset:3136
    v_mfma_f32_16x16x32_bf16 v[204:207], v[80:83], v[144:147], 0
    ds_read_b128 v[148:151], v7 offset:3648
    v_mfma_f32_16x16x32_bf16 v[200:203], v[80:83], v[140:143], v[200:203]
    s_add_u32 s61, s73, 0
    ds_read2_b32 v[180:181], v10 offset0:16 offset1:17
    buffer_store_dwordx4 v[248:251], v44, s[4:7], s61 offen sc1
    v_mfma_f32_16x16x32_bf16 v[196:199], v[80:83], v[136:139], v[196:199]
    s_add_u32 s61, s73, 1048576
    ds_read2_b32 v[182:183], v10 offset0:18 offset1:19
    s_waitcnt lgkmcnt(12)
    v_mfma_f32_16x16x32_bf16 v[208:211], v[164:167], v[144:147], 0
    ds_read2_b32 v[184:185], v10 offset0:144 offset1:145
    v_mfma_f32_16x16x32_bf16 v[204:207], v[164:167], v[140:143], v[204:207]
    ds_read2_b32 v[186:187], v10 offset0:146 offset1:147
    v_mfma_f32_16x16x32_bf16 v[200:203], v[164:167], v[136:139], v[200:203]
    ds_read2_b32 v[188:189], v11 offset0:16 offset1:17
    v_mfma_f32_16x16x32_bf16 v[196:199], v[164:167], v[132:135], v[196:199]
    ds_read2_b32 v[190:191], v11 offset0:18 offset1:19
    s_waitcnt lgkmcnt(14)
    v_mfma_f32_16x16x32_bf16 v[208:211], v[168:171], v[140:143], v[208:211]
    ds_read2_b32 v[192:193], v11 offset0:144 offset1:145
    buffer_store_dwordx4 v[248:251], v44, s[4:7], s61 offen sc1
    v_mfma_f32_16x16x32_bf16 v[204:207], v[168:171], v[136:139], v[204:207]
    ds_read2_b32 v[194:195], v11 offset0:146 offset1:147
    v_mfma_f32_16x16x32_bf16 v[200:203], v[168:171], v[132:135], v[200:203]
    s_waitcnt lgkmcnt(14)
    v_mfma_f32_16x16x32_bf16 v[208:211], v[172:175], v[136:139], v[208:211]
    v_mfma_f32_16x16x32_bf16 v[204:207], v[172:175], v[132:135], v[204:207]
    s_waitcnt lgkmcnt(12)
    v_mfma_f32_16x16x32_bf16 v[208:211], v[176:179], v[132:135], v[208:211]
    s_waitcnt lgkmcnt(0)
    v_mfma_f32_16x16x32_bf16 v[208:211], v[192:195], v[148:151], v[208:211]
    s_waitcnt vmcnt(3)
    ds_read_b128 v[144:147], v7 offset:2176
    v_min3_f32 v218, v218, v222, v226
    v_mfma_f32_16x16x32_bf16 v[208:211], v[188:191], v[152:155], v[208:211]
    ds_read_b128 v[140:143], v7 offset:2688
    v_max3_u32 v222, v212, v213, v214
    v_mfma_f32_16x16x32_bf16 v[208:211], v[184:187], v[156:159], v[208:211]
    ds_read_b128 v[136:139], v7 offset:3200
    v_min_f32 v218, v218, v230
    v_mfma_f32_16x16x32_bf16 v[208:211], v[180:183], v[160:163], v[208:211]
    ds_read_b128 v[132:135], v7 offset:3712
    v_max_u32 v222, v222, v215
    v_mfma_f32_16x16x32_bf16 v[204:207], v[188:191], v[148:151], v[204:207]
    ds_read2_b32 v[164:165], v10 offset0:32 offset1:33
    v_cmp_gt_f32 vcc, 0x41000000, v218
    v_mfma_f32_16x16x32_bf16 v[204:207], v[184:187], v[152:155], v[204:207]
    ds_read2_b32 v[166:167], v10 offset0:34 offset1:35
    v_cmp_eq_u32 s[20:21], -1, v222
    v_mfma_f32_16x16x32_bf16 v[204:207], v[180:183], v[156:159], v[204:207]
    s_nop 2
    s_or_b64 vcc, vcc, s[20:21]
    ds_read2_b32 v[168:169], v10 offset0:160 offset1:161
    v_mfma_f32_16x16x32_bf16 v[204:207], v[96:99], v[160:163], v[204:207]
    ds_read2_b32 v[170:171], v10 offset0:162 offset1:163
    s_cbranch_vccnz ps8
pe8:
    v_mfma_f32_16x16x32_bf16 v[200:203], v[184:187], v[148:151], v[200:203]
    ds_read2_b32 v[172:173], v11 offset0:32 offset1:33
    v_mul_f32 v216, s28, v216
    v_mfma_f32_16x16x32_bf16 v[200:203], v[180:183], v[152:155], v[200:203]
    ds_read2_b32 v[174:175], v11 offset0:34 offset1:35
    v_mul_f32 v220, s28, v220
    v_mfma_f32_16x16x32_bf16 v[200:203], v[96:99], v[156:159], v[200:203]
    ds_read2_b32 v[176:177], v11 offset0:160 offset1:161
    v_mul_f32 v224, s28, v224
    v_mfma_f32_16x16x32_bf16 v[200:203], v[92:95], v[160:163], v[200:203]
    ds_read2_b32 v[178:179], v11 offset0:162 offset1:163
    v_mul_f32 v228, s28, v228
    v_mfma_f32_16x16x32_bf16 v[196:199], v[180:183], v[148:151], v[196:199]
    v_fma_f32 v217, v217, s28, v254
    v_fma_f32 v221, v221, s28, v254
    v_mfma_f32_16x16x32_bf16 v[196:199], v[96:99], v[152:155], v[196:199]
    v_fma_f32 v225, v225, s28, v254
    v_fma_f32 v229, v229, s28, v254
    v_mfma_f32_16x16x32_bf16 v[196:199], v[92:95], v[156:159], v[196:199]
    v_fma_f32 v217, -v216, v216, v217
    v_fma_f32 v221, -v220, v220, v221
    v_mfma_f32_16x16x32_bf16 v[196:199], v[88:91], v[160:163], v[196:199]
    s_waitcnt lgkmcnt(0)
    v_fma_f32 v225, -v224, v224, v225
    v_fma_f32 v229, -v228, v228, v229
    v_mfma_f32_16x16x32_bf16 v[196:199], v[104:107], v[144:147], v[196:199]
    ds_read_b128 v[160:163], v7 offset:2240
    v_max_f32 v217, s29, v217
    v_mfma_f32_16x16x32_bf16 v[196:199], v[108:111], v[140:143], v[196:199]
    ds_read_b128 v[156:159], v7 offset:2752
    v_max_f32 v221, s29, v221
    v_mfma_f32_16x16x32_bf16 v[196:199], v[112:115], v[136:139], v[196:199]
    ds_read_b128 v[152:155], v7 offset:3264
    v_max_f32 v225, s29, v225
    v_mfma_f32_16x16x32_bf16 v[196:199], v[164:167], v[132:135], v[196:199]
    ds_read_b128 v[148:151], v7 offset:3776
    v_max_f32 v229, s29, v229
    v_mfma_f32_16x16x32_bf16 v[200:203], v[108:111], v[144:147], v[200:203]
    ds_read2_b32 v[180:181], v10 offset0:48 offset1:49
    v_rsq_f32 v217, v217
    v_mfma_f32_16x16x32_bf16 v[200:203], v[112:115], v[140:143], v[200:203]
    ds_read2_b32 v[182:183], v10 offset0:50 offset1:51
    v_rsq_f32 v221, v221
    v_mfma_f32_16x16x32_bf16 v[200:203], v[164:167], v[136:139], v[200:203]
    ds_read2_b32 v[184:185], v10 offset0:176 offset1:177
    v_rsq_f32 v225, v225
    v_mfma_f32_16x16x32_bf16 v[200:203], v[168:171], v[132:135], v[200:203]
    ds_read2_b32 v[186:187], v10 offset0:178 offset1:179
    v_rsq_f32 v229, v229
    v_mfma_f32_16x16x32_bf16 v[204:207], v[112:115], v[144:147], v[204:207]
    ds_read2_b32 v[188:189], v11 offset0:48 offset1:49
    v_lshlrev_b32 v232, 16, v212
    v_mfma_f32_16x16x32_bf16 v[204:207], v[164:167], v[140:143], v[204:207]
    ds_read2_b32 v[190:191], v11 offset0:50 offset1:51
    v_and_b32 v233, 0xffff0000, v212
    v_mfma_f32_16x16x32_bf16 v[204:207], v[168:171], v[136:139], v[204:207]
    ds_read2_b32 v[192:193], v11 offset0:176 offset1:177
    v_lshlrev_b32 v234, 16, v213
    v_mfma_f32_16x16x32_bf16 v[204:207], v[172:175], v[132:135], v[204:207]
    ds_read2_b32 v[194:195], v11 offset0:178 offset1:179
    v_and_b32 v235, 0xffff0000, v213
    v_mfma_f32_16x16x32_bf16 v[208:211], v[164:167], v[144:147], v[208:211]
    v_lshlrev_b32 v236, 16, v214
    v_and_b32 v237, 0xffff0000, v214
    v_mfma_f32_16x16x32_bf16 v[208:211], v[168:171], v[140:143], v[208:211]
    v_lshlrev_b32 v238, 16, v215
    v_and_b32 v239, 0xffff0000, v215
    v_mfma_f32_16x16x32_bf16 v[208:211], v[172:175], v[136:139], v[208:211]
    v_subrev_f32_dpp v240, v216, v232 quad_perm:[0,1,0,1] row_mask:0xf bank_mask:0xf
    v_subrev_f32_dpp v241, v220, v233 quad_perm:[0,1,0,1] row_mask:0xf bank_mask:0xf
    v_mfma_f32_16x16x32_bf16 v[208:211], v[176:179], v[132:135], v[208:211]
    s_waitcnt lgkmcnt(0)
    v_subrev_f32_dpp v242, v224, v234 quad_perm:[0,1,0,1] row_mask:0xf bank_mask:0xf
    v_subrev_f32_dpp v243, v228, v235 quad_perm:[0,1,0,1] row_mask:0xf bank_mask:0xf
    v_mfma_f32_16x16x32_bf16 v[208:211], v[192:195], v[148:151], v[208:211]
    v_subrev_f32_dpp v244, v216, v236 quad_perm:[2,3,2,3] row_mask:0xf bank_mask:0xf
    v_subrev_f32_dpp v245, v220, v237 quad_perm:[2,3,2,3] row_mask:0xf bank_mask:0xf
    v_mfma_f32_16x16x32_bf16 v[208:211], v[188:191], v[152:155], v[208:211]
    v_subrev_f32_dpp v246, v224, v238 quad_perm:[2,3,2,3] row_mask:0xf bank_mask:0xf
    v_subrev_f32_dpp v247, v228, v239 quad_perm:[2,3,2,3] row_mask:0xf bank_mask:0xf
    v_mfma_f32_16x16x32_bf16 v[208:211], v[184:187], v[156:159], v[208:211]
    v_mul_f32_dpp v240, v217, v240 quad_perm:[0,1,0,1] row_mask:0xf bank_mask:0xf
    v_mul_f32_dpp v241, v221, v241 quad_perm:[0,1,0,1] row_mask:0xf bank_mask:0xf
    v_mfma_f32_16x16x32_bf16 v[208:211], v[180:183], v[160:163], v[208:211]
    v_mul_f32_dpp v242, v225, v242 quad_perm:[0,1,0,1] row_mask:0xf bank_mask:0xf
    v_mul_f32_dpp v243, v229, v243 quad_perm:[0,1,0,1] row_mask:0xf bank_mask:0xf
    v_mfma_f32_16x16x32_bf16 v[204:207], v[188:191], v[148:151], v[204:207]
    v_mul_f32_dpp v244, v217, v244 quad_perm:[2,3,2,3] row_mask:0xf bank_mask:0xf
    v_mul_f32_dpp v245, v221, v245 quad_perm:[2,3,2,3] row_mask:0xf bank_mask:0xf
    v_mfma_f32_16x16x32_bf16 v[204:207], v[184:187], v[152:155], v[204:207]
    v_mul_f32_dpp v246, v225, v246 quad_perm:[2,3,2,3] row_mask:0xf bank_mask:0xf
    v_mul_f32_dpp v247, v229, v247 quad_perm:[2,3,2,3] row_mask:0xf bank_mask:0xf
    v_mfma_f32_16x16x32_bf16 v[204:207], v[180:183], v[156:159], v[204:207]
    v_cvt_pk_bf16_f32 v212, v247, v246
    v_cvt_pk_bf16_f32 v213, v245, v244
    v_mfma_f32_16x16x32_bf16 v[204:207], v[128:131], v[160:163], v[204:207]
    v_cvt_pk_bf16_f32 v214, v243, v242
    v_cvt_pk_bf16_f32 v215, v241, v240
    v_mfma_f32_16x16x32_bf16 v[200:203], v[184:187], v[148:151], v[200:203]
    ds_write_b128 v15, v[212:215] offset:0
    v_mfma_f32_16x16x32_bf16 v[200:203], v[180:183], v[152:155], v[200:203]
    v_mfma_f32_16x16x32_bf16 v[200:203], v[128:131], v[156:159], v[200:203]
    v_mfma_f32_16x16x32_bf16 v[200:203], v[124:127], v[160:163], v[200:203]
    v_mfma_f32_16x16x32_bf16 v[196:199], v[180:183], v[148:151], v[196:199]
    s_waitcnt lgkmcnt(0)
    v_mfma_f32_16x16x32_bf16 v[196:199], v[128:131], v[152:155], v[196:199]
    s_barrier
    ds_read_b128 v[132:135], v7 offset:1536
    v_mfma_f32_16x16x32_bf16 v[196:199], v[124:127], v[156:159], v[196:199]
    ds_read_b128 v[136:139], v7 offset:1024
    v_mfma_f32_16x16x32_bf16 v[196:199], v[120:123], v[160:163], v[196:199]
    ds_read_b128 v[140:143], v7 offset:512
    ds_read_b128 v[144:147], v7 offset:0
    s_waitcnt lgkmcnt(3)
    v_mfma_f32_16x16x32_bf16 v[196:199], v[68:71], v[132:135], v[196:199]
    ds_read_b128 v[148:151], v7 offset:1600
    v_fmac_f32 v232, v66, v240
    v_mfma_f32_16x16x32_bf16 v[200:203], v[72:75], v[132:135], v[200:203]
    ds_read_b128 v[152:155], v7 offset:1088
    v_fmac_f32 v233, v66, v241
    s_waitcnt lgkmcnt(4)
    v_mfma_f32_16x16x32_bf16 v[200:203], v[68:71], v[136:139], v[200:203]
    ds_read_b128 v[156:159], v7 offset:576
    v_fmac_f32 v234, v66, v242
    v_mfma_f32_16x16x32_bf16 v[204:207], v[76:79], v[132:135], v[204:207]
    ds_read_b128 v[160:163], v7 offset:64
    v_fmac_f32 v235, v66, v243
    v_mfma_f32_16x16x32_bf16 v[204:207], v[72:75], v[136:139], v[204:207]
    v_fmac_f32 v236, v66, v244
    s_waitcnt lgkmcnt(5)
    v_mfma_f32_16x16x32_bf16 v[204:207], v[68:71], v[140:143], v[204:207]
    v_fmac_f32 v237, v66, v245
    v_mfma_f32_16x16x32_bf16 v[208:211], v[80:83], v[132:135], v[208:211]
    v_fmac_f32 v238, v66, v246
    v_mfma_f32_16x16x32_bf16 v[208:211], v[76:79], v[136:139], v[208:211]
    v_fmac_f32 v239, v66, v247
    v_mfma_f32_16x16x32_bf16 v[208:211], v[72:75], v[140:143], v[208:211]
    s_waitcnt lgkmcnt(4)
    v_mfma_f32_16x16x32_bf16 v[208:211], v[68:71], v[144:147], v[208:211]
    s_waitcnt lgkmcnt(0)
    v_mfma_f32_16x16x32_bf16 v[208:211], v[84:87], v[160:163], v[208:211]
    ds_read_b128 v[132:135], v7 offset:1664
    v_mfma_f32_16x16x32_bf16 v[208:211], v[88:91], v[156:159], v[208:211]
    ds_read_b128 v[136:139], v7 offset:1152
    v_mfma_f32_16x16x32_bf16 v[208:211], v[92:95], v[152:155], v[208:211]
    s_add_u32 s36, s64, 0
    s_add_u32 s38, s36, 16384
    ds_read_b128 v[140:143], v7 offset:640
    v_mfma_f32_16x16x32_bf16 v[208:211], v[96:99], v[148:151], v[208:211]
    s_sub_u32 s37, s36, s65
    s_add_u32 m0, s66, 65536
    ds_read_b128 v[144:147], v7 offset:128
    v_mfma_f32_16x16x32_bf16 v[204:207], v[84:87], v[156:159], v[204:207]
    buffer_load_dwordx4 v4, s[4:7], s37 offen offset:0 sc1 lds
    s_add_u32 m0, s66, 0
    v_mfma_f32_16x16x32_bf16 v[204:207], v[88:91], v[152:155], v[204:207]
    v_mfma_f32_16x16x32_bf16 v[204:207], v[92:95], v[148:151], v[204:207]
    v_mfma_f32_16x16x32_bf16 v[200:203], v[84:87], v[152:155], v[200:203]
    buffer_load_dwordx4 v4, s[4:7], s36 offen offset:0 sc1 lds
    s_add_u32 m0, s66, 16384
    v_mfma_f32_16x16x32_bf16 v[200:203], v[88:91], v[148:151], v[200:203]
    v_mfma_f32_16x16x32_bf16 v[196:199], v[84:87], v[148:151], v[196:199]
    s_waitcnt lgkmcnt(0)
    v_mfma_f32_16x16x32_bf16 v[208:211], v[100:103], v[144:147], v[208:211]
    ds_read_b128 v[148:151], v7 offset:1728
    buffer_load_dwordx4 v4, s[4:7], s38 offen offset:0 sc1 lds
    v_mfma_f32_16x16x32_bf16 v[208:211], v[104:107], v[140:143], v[208:211]
    s_add_u32 m0, s66, 65536
    ds_read_b128 v[152:155], v7 offset:1216
    v_mfma_f32_16x16x32_bf16 v[208:211], v[108:111], v[136:139], v[208:211]
    ds_read_b128 v[156:159], v7 offset:704
    v_mfma_f32_16x16x32_bf16 v[208:211], v[112:115], v[132:135], v[208:211]
    ds_read_b128 v[160:163], v7 offset:192
    buffer_load_dwordx4 v4, s[4:7], s37 offen offset:1024 sc1 lds
    v_mfma_f32_16x16x32_bf16 v[204:207], v[100:103], v[140:143], v[204:207]
    s_add_u32 m0, s66, 0
    v_mfma_f32_16x16x32_bf16 v[204:207], v[104:107], v[136:139], v[204:207]
    v_mfma_f32_16x16x32_bf16 v[204:207], v[108:111], v[132:135], v[204:207]
    buffer_load_dwordx4 v4, s[4:7], s36 offen offset:1024 sc1 lds
    s_add_u32 m0, s66, 16384
    v_mfma_f32_16x16x32_bf16 v[200:203], v[100:103], v[136:139], v[200:203]
    v_mfma_f32_16x16x32_bf16 v[200:203], v[104:107], v[132:135], v[200:203]
    v_mfma_f32_16x16x32_bf16 v[196:199], v[100:103], v[132:135], v[196:199]
    s_waitcnt lgkmcnt(0)
    buffer_load_dwordx4 v4, s[4:7], s38 offen offset:1024 sc1 lds
    s_add_u32 m0, s66, 65536
    v_mfma_f32_16x16x32_bf16 v[196:199], v[116:119], v[148:151], v[196:199]
    v_mfma_f32_16x16x32_bf16 v[200:203], v[120:123], v[148:151], v[200:203]
    v_mfma_f32_16x16x32_bf16 v[200:203], v[116:119], v[152:155], v[200:203]
    buffer_load_dwordx4 v4, s[4:7], s37 offen offset:2048 sc1 lds
    s_add_u32 m0, s66, 0
    v_mfma_f32_16x16x32_bf16 v[204:207], v[124:127], v[148:151], v[204:207]
    v_mfma_f32_16x16x32_bf16 v[204:207], v[120:123], v[152:155], v[204:207]
    s_nop 1
    ds_write_b128 v12, v[196:199] offset:0
    v_mfma_f32_16x16x32_bf16 v[204:207], v[116:119], v[156:159], v[204:207]
    buffer_load_dwordx4 v4, s[4:7], s36 offen offset:2048 sc1 lds
    s_add_u32 m0, s66, 16384
    v_mfma_f32_16x16x32_bf16 v[208:211], v[128:131], v[148:151], v[208:211]
    v_mfma_f32_16x16x32_bf16 v[208:211], v[124:127], v[152:155], v[208:211]
    ds_write_b128 v12, v[200:203] offset:1024
    v_mfma_f32_16x16x32_bf16 v[208:211], v[120:123], v[156:159], v[208:211]
    buffer_load_dwordx4 v4, s[4:7], s38 offen offset:2048 sc1 lds
    s_add_u32 m0, s66, 65536
    v_mfma_f32_16x16x32_bf16 v[208:211], v[116:119], v[160:163], v[208:211]
    ds_write_b128 v12, v[204:207] offset:2048
    s_nop 6
    ds_write_b128 v12, v[208:211] offset:3072
    s_add_u32 s22, s75, 7340032
    buffer_load_dwordx4 v4, s[4:7], s37 offen offset:3072 sc1 lds
    s_add_u32 m0, s66, 0
    s_nop 0
    buffer_load_dwordx4 v4, s[4:7], s36 offen offset:3072 sc1 lds
    s_waitcnt vmcnt(11)
    s_waitcnt lgkmcnt(0)
    s_barrier
    ds_read_b128 v[164:167], v13 offset:0
    ds_read_b128 v[168:171], v14 offset:0
    ds_read_b128 v[172:175], v13 offset:4096
    ds_read_b128 v[176:179], v14 offset:4096
    s_add_u32 m0, s66, 16384
    s_nop 0
    buffer_load_dwordx4 v4, s[4:7], s38 offen offset:3072 sc1 lds
    s_waitcnt lgkmcnt(3)
    v_add_f32 v232, v232, v164
    v_add_f32 v233, v233, v165
    v_add_f32 v234, v234, v166
    v_add_f32 v235, v235, v167
    s_waitcnt lgkmcnt(2)
    v_add_f32 v236, v236, v168
    v_add_f32 v237, v237, v169
    v_add_f32 v238, v238, v170
    v_add_f32 v239, v239, v171
    s_waitcnt lgkmcnt(1)
    v_add_f32 v232, v232, v172
    v_add_f32 v233, v233, v173
    v_add_f32 v234, v234, v174
    v_add_f32 v235, v235, v175
    s_waitcnt lgkmcnt(0)
    v_add_f32 v236, v236, v176
    v_add_f32 v237, v237, v177
    v_add_f32 v238, v238, v178
    v_add_f32 v239, v239, v179
    v_cvt_pk_bf16_f32 v240, v232, v233
    v_cvt_pk_bf16_f32 v241, v234, v235
    v_cvt_pk_bf16_f32 v242, v236, v237
    v_cvt_pk_bf16_f32 v243, v238, v239
iw5:
    s_cbranch_execz iw_back
    buffer_store_dwordx4 v[240:243], v5, s[4:7], s22 offen sc1
    s_waitcnt vmcnt(7)
    ds_read_b64_tr_b16 v[124:125], v43 offset:0
    ds_read_b64_tr_b16 v[126:127], v43 offset:512
    ds_read_b64_tr_b16 v[128:129], v42 offset:0
    ds_read_b64_tr_b16 v[130:131], v42 offset:512
    ds_read_b64_tr_b16 v[132:133], v42 offset:16384
    ds_read_b64_tr_b16 v[134:135], v42 offset:16896
    ds_read_b64_tr_b16 v[136:137], v43 offset:1024
    ds_read_b64_tr_b16 v[138:139], v43 offset:1536
    ds_read_b64_tr_b16 v[140:141], v42 offset:1024
    ds_read_b64_tr_b16 v[142:143], v42 offset:1536
    ds_read_b64_tr_b16 v[144:145], v42 offset:17408
    ds_read_b64_tr_b16 v[146:147], v42 offset:17920
    s_waitcnt lgkmcnt(10)
    v_mfma_f32_16x16x32_bf16 v[112:115], v[16:19], v[124:127], 0
    s_waitcnt vmcnt(1)
    ds_read_b64_tr_b16 v[148:149], v43 offset:2048
    ds_read_b64_tr_b16 v[150:151], v43 offset:2560
    s_waitcnt lgkmcnt(10)
    v_mfma_f32_16x16x32_bf16 v[116:119], v[16:19], v[128:131], 0
    ds_read_b64_tr_b16 v[152:153], v42 offset:2048
    ds_read_b64_tr_b16 v[154:155], v42 offset:2560
    s_waitcnt lgkmcnt(10)
    v_mfma_f32_16x16x32_bf16 v[120:123], v[16:19], v[132:135], 0
    ds_read_b64_tr_b16 v[156:157], v42 offset:18432
    ds_read_b64_tr_b16 v[158:159], v42 offset:18944
    v_mfma_f32_16x16x32_bf16 v[100:103], v[124:127], v[124:127], 0
    ds_read_b64_tr_b16 v[178:179], v43 offset:3072
    ds_read_b64_tr_b16 v[180:181], v43 offset:3584
    v_mfma_f32_16x16x32_bf16 v[104:107], v[128:131], v[128:131], 0
    ds_read_b64_tr_b16 v[182:183], v42 offset:3072
    ds_read_b64_tr_b16 v[184:185], v42 offset:3584
    v_mfma_f32_16x16x32_bf16 v[108:111], v[132:135], v[132:135], 0
    s_waitcnt lgkmcnt(10)
    ds_read_b64_tr_b16 v[186:187], v42 offset:19456
    ds_read_b64_tr_b16 v[188:189], v42 offset:19968
    v_mfma_f32_16x16x32_bf16 v[112:115], v[16:19], v[136:139], v[112:115]
    v_mfma_f32_16x16x32_bf16 v[116:119], v[16:19], v[140:143], v[116:119]
    v_mfma_f32_16x16x32_bf16 v[120:123], v[16:19], v[144:147], v[120:123]
    s_waitcnt lgkmcnt(6)
    v_mfma_f32_16x16x32_bf16 v[112:115], v[16:19], v[148:151], v[112:115]
    v_mfma_f32_16x16x32_bf16 v[116:119], v[16:19], v[152:155], v[116:119]
    v_mfma_f32_16x16x32_bf16 v[120:123], v[16:19], v[156:159], v[120:123]
    s_waitcnt lgkmcnt(0)
    v_mfma_f32_16x16x32_bf16 v[112:115], v[16:19], v[178:181], v[112:115]
    v_mfma_f32_16x16x32_bf16 v[116:119], v[16:19], v[182:185], v[116:119]
    v_mfma_f32_16x16x32_bf16 v[120:123], v[16:19], v[186:189], v[120:123]
    v_mfma_f32_16x16x32_bf16 v[100:103], v[136:139], v[136:139], v[100:103]
    v_mfma_f32_16x16x32_bf16 v[104:107], v[140:143], v[140:143], v[104:107]
    v_mfma_f32_16x16x32_bf16 v[108:111], v[144:147], v[144:147], v[108:111]
    s_nop 3
    v_add_f32 v252, v112, v116
    v_cmp_u_f32 vcc, v252, v120
    v_mfma_f32_16x16x32_bf16 v[100:103], v[148:151], v[148:151], v[100:103]
    s_cbranch_vccnz sr10
so10:
    v_mfma_f32_16x16x32_bf16 v[104:107], v[152:155], v[152:155], v[104:107]
    s_barrier
    ds_read_b64_tr_b16 v[124:125], v41 offset:0
    ds_read_b64_tr_b16 v[126:127], v41 offset:512
    v_mfma_f32_16x16x32_bf16 v[108:111], v[156:159], v[156:159], v[108:111]
    ds_read_b64_tr_b16 v[128:129], v40 offset:0
    ds_read_b64_tr_b16 v[130:131], v40 offset:512
    v_mfma_f32_16x16x32_bf16 v[100:103], v[178:181], v[178:181], v[100:103]
    ds_read_b64_tr_b16 v[132:133], v40 offset:16384
    ds_read_b64_tr_b16 v[134:135], v40 offset:16896
    v_mfma_f32_16x16x32_bf16 v[104:107], v[182:185], v[182:185], v[104:107]
    ds_read_b64_tr_b16 v[136:137], v41 offset:1024
    ds_read_b64_tr_b16 v[138:139], v41 offset:1536
    v_mfma_f32_16x16x32_bf16 v[108:111], v[186:189], v[186:189], v[108:111]
    ds_read_b64_tr_b16 v[140:141], v40 offset:1024
    ds_read_b64_tr_b16 v[142:143], v40 offset:1536
    ds_read_b64_tr_b16 v[144:145], v40 offset:17408
    ds_read_b64_tr_b16 v[146:147], v40 offset:17920
    s_waitcnt lgkmcnt(10)
    v_mfma_f32_16x16x32_bf16 v[76:79], a[4:7], v[124:127], 0
    ds_read_b64_tr_b16 v[148:149], v41 offset:2048
    v_mfma_f32_16x16x32_bf16 v[88:91], v[124:127], a[8:11], 0
    ds_read_b64_tr_b16 v[150:151], v41 offset:2560
    v_cndmask_b32 v113, v100, v101, s[48:49]
    s_waitcnt lgkmcnt(10)
    v_mfma_f32_16x16x32_bf16 v[68:71], a[0:3], v[128:131], 0
    ds_read_b64_tr_b16 v[152:153], v40 offset:2048
    v_cndmask_b32 v113, v113, v102, s[50:51]
    v_mfma_f32_16x16x32_bf16 v[80:83], a[4:7], v[128:131], 0
    ds_read_b64_tr_b16 v[154:155], v40 offset:2560
    v_cndmask_b32 v113, v113, v103, s[52:53]
    v_mfma_f32_16x16x32_bf16 v[92:95], v[128:131], a[8:11], 0
    ds_read_b64_tr_b16 v[156:157], v40 offset:18432
    v_cndmask_b32 v117, v104, v105, s[48:49]
    s_waitcnt lgkmcnt(11)
    v_mfma_f32_16x16x32_bf16 v[72:75], a[0:3], v[132:135], 0
    ds_read_b64_tr_b16 v[158:159], v40 offset:18944
    v_cndmask_b32 v117, v117, v106, s[50:51]
    v_mfma_f32_16x16x32_bf16 v[84:87], a[4:7], v[132:135], 0
    ds_read_b64_tr_b16 v[124:125], v41 offset:3072
    v_cndmask_b32 v117, v117, v107, s[52:53]
    v_mfma_f32_16x16x32_bf16 v[96:99], v[132:135], a[8:11], 0
    s_waitcnt lgkmcnt(7)
    ds_read_b64_tr_b16 v[126:127], v41 offset:3584
    v_cndmask_b32 v121, v108, v109, s[48:49]
    v_mfma_f32_16x16x32_bf16 v[76:79], a[16:19], v[136:139], v[76:79]
    ds_read_b64_tr_b16 v[128:129], v40 offset:3072
    v_cndmask_b32 v121, v121, v110, s[50:51]
    v_mfma_f32_16x16x32_bf16 v[88:91], v[136:139], a[20:23], v[88:91]
    ds_read_b64_tr_b16 v[130:131], v40 offset:3584
    v_cndmask_b32 v121, v121, v111, s[52:53]
    v_mfma_f32_16x16x32_bf16 v[68:71], a[12:15], v[140:143], v[68:71]
    ds_write_b64 v52, v[112:113] offset:0
    v_mfma_f32_16x16x32_bf16 v[80:83], a[16:19], v[140:143], v[80:83]
    ds_read_b64_tr_b16 v[132:133], v40 offset:19456
    ds_write_b64 v52, v[116:117] offset:128
    v_mfma_f32_16x16x32_bf16 v[92:95], v[140:143], a[20:23], v[92:95]
    ds_read_b64_tr_b16 v[134:135], v40 offset:19968
    ds_write_b64 v52, v[120:121] offset:256
    v_mfma_f32_16x16x32_bf16 v[72:75], a[12:15], v[144:147], v[72:75]
    v_mfma_f32_16x16x32_bf16 v[84:87], a[16:19], v[144:147], v[84:87]
    ds_read_b64_tr_b16 v[136:137], v41 offset:4096
    v_mfma_f32_16x16x32_bf16 v[96:99], v[144:147], a[20:23], v[96:99]
    s_waitcnt lgkmcnt(10)
    ds_read_b64_tr_b16 v[138:139], v41 offset:4608
    v_mfma_f32_16x16x32_bf16 v[76:79], a[28:31], v[148:151], v[76:79]
    ds_read_b64_tr_b16 v[140:141], v40 offset:4096
    v_mfma_f32_16x16x32_bf16 v[88:91], v[148:151], a[32:35], v[88:91]
    ds_read_b64_tr_b16 v[142:143], v40 offset:4608
    v_mfma_f32_16x16x32_bf16 v[68:71], a[24:27], v[152:155], v[68:71]
    s_waitcnt lgkmcnt(4)
    s_barrier
    ds_read_b64 v[160:161], v53 offset:0
    v_mfma_f32_16x16x32_bf16 v[80:83], a[28:31], v[152:155], v[80:83]
    ds_read_b64_tr_b16 v[144:145], v40 offset:20480
    ds_read_b64 v[162:163], v53 offset:512
    v_mfma_f32_16x16x32_bf16 v[92:95], v[152:155], a[32:35], v[92:95]
    ds_read_b64_tr_b16 v[146:147], v40 offset:20992
    ds_read_b64 v[164:165], v53 offset:1024
    v_mfma_f32_16x16x32_bf16 v[72:75], a[24:27], v[156:159], v[72:75]
    ds_read_b64 v[166:167], v53 offset:1536
    v_mfma_f32_16x16x32_bf16 v[84:87], a[28:31], v[156:159], v[84:87]
    ds_read_b64_tr_b16 v[148:149], v41 offset:5120
    v_mfma_f32_16x16x32_bf16 v[96:99], v[156:159], a[32:35], v[96:99]
    ds_read_b64_tr_b16 v[150:151], v41 offset:5632
    v_mfma_f32_16x16x32_bf16 v[76:79], a[40:43], v[124:127], v[76:79]
    ds_read_b64_tr_b16 v[152:153], v40 offset:5120
    v_mfma_f32_16x16x32_bf16 v[88:91], v[124:127], a[44:47], v[88:91]
    ds_read_b64_tr_b16 v[154:155], v40 offset:5632
    v_mfma_f32_16x16x32_bf16 v[68:71], a[36:39], v[128:131], v[68:71]
    v_mfma_f32_16x16x32_bf16 v[80:83], a[40:43], v[128:131], v[80:83]
    ds_read_b64_tr_b16 v[156:157], v40 offset:21504
    v_mfma_f32_16x16x32_bf16 v[92:95], v[128:131], a[44:47], v[92:95]
    s_waitcnt lgkmcnt(5)
    ds_read_b64_tr_b16 v[158:159], v40 offset:22016
    v_add_f32 v160, v160, v162
    v_mfma_f32_16x16x32_bf16 v[72:75], a[36:39], v[132:135], v[72:75]
    v_add_f32 v161, v161, v163
    v_mfma_f32_16x16x32_bf16 v[84:87], a[40:43], v[132:135], v[84:87]
    ds_read_b64_tr_b16 v[124:125], v41 offset:6144
    v_add_f32 v164, v164, v166
    v_mfma_f32_16x16x32_bf16 v[96:99], v[132:135], a[44:47], v[96:99]
    ds_read_b64_tr_b16 v[126:127], v41 offset:6656
    v_add_f32 v165, v165, v167
    v_mfma_f32_16x16x32_bf16 v[76:79], a[52:55], v[136:139], v[76:79]
    ds_read_b64_tr_b16 v[128:129], v40 offset:6144
    v_add_f32 v160, v160, v164
    v_mfma_f32_16x16x32_bf16 v[88:91], v[136:139], a[56:59], v[88:91]
    ds_read_b64_tr_b16 v[130:131], v40 offset:6656
    v_add_f32 v161, v161, v165
    v_mfma_f32_16x16x32_bf16 v[68:71], a[48:51], v[140:143], v[68:71]
    v_mul_f32 v170, s28, v160
    v_mfma_f32_16x16x32_bf16 v[80:83], a[52:55], v[140:143], v[80:83]
    s_add_u32 s36, s64, 1048576
    s_add_u32 s38, s36, 16384
    ds_read_b64_tr_b16 v[132:133], v40 offset:22528
    v_mfma_f32_16x16x32_bf16 v[92:95], v[140:143], a[56:59], v[92:95]
    s_sub_u32 s37, s36, 16384
    s_add_u32 m0, s66, 81920
    ds_read_b64_tr_b16 v[134:135], v40 offset:23040
    v_mfma_f32_16x16x32_bf16 v[72:75], a[48:51], v[144:147], v[72:75]
    buffer_load_dwordx4 v4, s[4:7], s37 offen offset:0 sc1 lds
    s_add_u32 m0, s66, 32768
    v_mfma_f32_16x16x32_bf16 v[84:87], a[52:55], v[144:147], v[84:87]
    ds_read_b64_tr_b16 v[136:137], v41 offset:7168
    v_mul_f32 v161, s28, v161
    v_mfma_f32_16x16x32_bf16 v[96:99], v[144:147], a[56:59], v[96:99]
    s_waitcnt lgkmcnt(7)
    ds_read_b64_tr_b16 v[138:139], v41 offset:7680
    v_fma_f32 v161, -v170, v170, v161
    v_mfma_f32_16x16x32_bf16 v[76:79], a[64:67], v[148:151], v[76:79]
    ds_read_b64_tr_b16 v[140:141], v40 offset:7168
    v_max_f32 v161, 0, v161
    v_mfma_f32_16x16x32_bf16 v[88:91], v[148:151], a[68:71], v[88:91]
    ds_read_b64_tr_b16 v[142:143], v40 offset:7680
    buffer_load_dwordx4 v4, s[4:7], s36 offen offset:0 sc1 lds
    v_mfma_f32_16x16x32_bf16 v[68:71], a[60:63], v[152:155], v[68:71]
    s_add_u32 m0, s66, 49152
    v_add_f32 v161, s29, v161
    v_mfma_f32_16x16x32_bf16 v[80:83], a[64:67], v[152:155], v[80:83]
    ds_read_b64_tr_b16 v[144:145], v40 offset:23552
    v_sqrt_f32 v161, v161
    v_mfma_f32_16x16x32_bf16 v[92:95], v[152:155], a[68:71], v[92:95]
    ds_read_b64_tr_b16 v[146:147], v40 offset:24064
    v_cvt_pk_bf16_f32 v162, v161, v161
    v_mfma_f32_16x16x32_bf16 v[72:75], a[60:63], v[156:159], v[72:75]
    buffer_load_dwordx4 v4, s[4:7], s38 offen offset:0 sc1 lds
    s_add_u32 m0, s66, 81920
    v_mfma_f32_16x16x32_bf16 v[84:87], a[64:67], v[156:159], v[84:87]
    ds_read_b64_tr_b16 v[148:149], v41 offset:8192
    v_and_b32 v161, 0xffff0000, v162
    v_mfma_f32_16x16x32_bf16 v[96:99], v[156:159], a[68:71], v[96:99]
    s_waitcnt lgkmcnt(7)
    ds_read_b64_tr_b16 v[150:151], v41 offset:8704
    v_rcp_f32 v168, v161
    v_mfma_f32_16x16x32_bf16 v[76:79], a[76:79], v[124:127], v[76:79]
    ds_read_b64_tr_b16 v[152:153], v40 offset:8192
    v_log_f32 v169, v161
    v_mfma_f32_16x16x32_bf16 v[88:91], v[124:127], a[80:83], v[88:91]
    ds_read_b64_tr_b16 v[154:155], v40 offset:8704
    buffer_load_dwordx4 v4, s[4:7], s37 offen offset:1024 sc1 lds
    v_mfma_f32_16x16x32_bf16 v[68:71], a[72:75], v[128:131], v[68:71]
    s_add_u32 m0, s66, 32768
    v_mov_b32 v171, v168
    v_mfma_f32_16x16x32_bf16 v[80:83], a[76:79], v[128:131], v[80:83]
    ds_read_b64_tr_b16 v[156:157], v40 offset:24576
    ds_write_b128 v54, v[168:171]
    v_mfma_f32_16x16x32_bf16 v[92:95], v[128:131], a[80:83], v[92:95]
    ds_read_b64_tr_b16 v[158:159], v40 offset:25088
    ds_write_b16 v55, v162
    v_mfma_f32_16x16x32_bf16 v[72:75], a[72:75], v[132:135], v[72:75]
    buffer_load_dwordx4 v4, s[4:7], s36 offen offset:1024 sc1 lds
    s_add_u32 m0, s66, 49152
    v_mfma_f32_16x16x32_bf16 v[84:87], a[76:79], v[132:135], v[84:87]
    ds_read_b64_tr_b16 v[124:125], v41 offset:9216
    ds_read_b64 v[172:173], v56 offset:8
    v_mfma_f32_16x16x32_bf16 v[96:99], v[132:135], a[80:83], v[96:99]
    s_waitcnt lgkmcnt(10)
    ds_read_b64_tr_b16 v[126:127], v41 offset:9728
    ds_read_b64 v[174:175], v56 offset:264
    v_mfma_f32_16x16x32_bf16 v[76:79], a[88:91], v[136:139], v[76:79]
    ds_read_b64_tr_b16 v[128:129], v40 offset:9216
    ds_read_b64 v[176:177], v56 offset:520
    v_mfma_f32_16x16x32_bf16 v[88:91], v[136:139], a[92:95], v[88:91]
    ds_read_b64_tr_b16 v[130:131], v40 offset:9728
    buffer_load_dwordx4 v4, s[4:7], s38 offen offset:1024 sc1 lds
    v_mfma_f32_16x16x32_bf16 v[68:71], a[84:87], v[140:143], v[68:71]
    s_add_u32 m0, s66, 81920
    ds_read2_b32 v[178:179], v57 offset0:2 offset1:6
    v_mfma_f32_16x16x32_bf16 v[80:83], a[88:91], v[140:143], v[80:83]
    ds_read_b64_tr_b16 v[132:133], v40 offset:25600
    ds_read2_b32 v[180:181], v57 offset0:10 offset1:14
    v_mfma_f32_16x16x32_bf16 v[92:95], v[140:143], a[92:95], v[92:95]
    ds_read_b64_tr_b16 v[134:135], v40 offset:26112
    ds_read2_b32 v[182:183], v57 offset0:66 offset1:70
    v_mfma_f32_16x16x32_bf16 v[72:75], a[84:87], v[144:147], v[72:75]
    buffer_load_dwordx4 v4, s[4:7], s37 offen offset:2048 sc1 lds
    s_add_u32 m0, s66, 32768
    v_mfma_f32_16x16x32_bf16 v[84:87], a[88:91], v[144:147], v[84:87]
    ds_read_b64_tr_b16 v[136:137], v41 offset:10240
    ds_read2_b32 v[184:185], v57 offset0:74 offset1:78
    v_mfma_f32_16x16x32_bf16 v[96:99], v[144:147], a[92:95], v[96:99]
    s_waitcnt lgkmcnt(15)
    ds_read_b64_tr_b16 v[138:139], v41 offset:10752
    ds_read2_b32 v[186:187], v57 offset0:130 offset1:134
    v_mfma_f32_16x16x32_bf16 v[76:79], a[100:103], v[148:151], v[76:79]
    ds_read_b64_tr_b16 v[140:141], v40 offset:10240
    ds_read2_b32 v[188:189], v57 offset0:138 offset1:142
    v_mfma_f32_16x16x32_bf16 v[88:91], v[148:151], a[104:107], v[88:91]
    ds_read_b64_tr_b16 v[142:143], v40 offset:10752
    buffer_load_dwordx4 v4, s[4:7], s36 offen offset:2048 sc1 lds
    v_mfma_f32_16x16x32_bf16 v[68:71], a[96:99], v[152:155], v[68:71]
    s_add_u32 m0, s66, 49152
    v_mfma_f32_16x16x32_bf16 v[80:83], a[100:103], v[152:155], v[80:83]
    s_waitcnt lgkmcnt(1)
    ds_read_b64_tr_b16 v[144:145], v40 offset:26624
    v_mfma_f32_16x16x32_bf16 v[92:95], v[152:155], a[104:107], v[92:95]
    ds_read_b64_tr_b16 v[146:147], v40 offset:27136
    v_fma_f32 v76, -v24, v172, v76
    v_mfma_f32_16x16x32_bf16 v[72:75], a[96:99], v[156:159], v[72:75]
    buffer_load_dwordx4 v4, s[4:7], s38 offen offset:2048 sc1 lds
    v_fma_f32 v88, -v178, v28, v88
    v_mfma_f32_16x16x32_bf16 v[84:87], a[100:103], v[156:159], v[84:87]
    s_add_u32 m0, s66, 81920
    ds_read_b64_tr_b16 v[148:149], v41 offset:11264
    v_fma_f32 v68, -v20, v174, v68
    v_mfma_f32_16x16x32_bf16 v[96:99], v[156:159], a[104:107], v[96:99]
    ds_read_b64_tr_b16 v[150:151], v41 offset:11776
    v_fma_f32 v80, -v24, v174, v80
    v_mfma_f32_16x16x32_bf16 v[76:79], a[112:115], v[124:127], v[76:79]
    ds_read_b64_tr_b16 v[152:153], v40 offset:11264
    v_fma_f32 v92, -v182, v28, v92
    v_mfma_f32_16x16x32_bf16 v[88:91], v[124:127], a[116:119], v[88:91]
    ds_read_b64_tr_b16 v[154:155], v40 offset:11776
    v_fma_f32 v72, -v20, v176, v72
    v_mfma_f32_16x16x32_bf16 v[68:71], a[108:111], v[128:131], v[68:71]
    buffer_load_dwordx4 v4, s[4:7], s37 offen offset:3072 sc1 lds
    v_fma_f32 v84, -v24, v176, v84
    v_mfma_f32_16x16x32_bf16 v[80:83], a[112:115], v[128:131], v[80:83]
    s_add_u32 m0, s66, 32768
    ds_read_b64_tr_b16 v[156:157], v40 offset:27648
    v_fma_f32 v96, -v186, v28, v96
    v_mfma_f32_16x16x32_bf16 v[92:95], v[128:131], a[116:119], v[92:95]
    ds_read_b64_tr_b16 v[158:159], v40 offset:28160
    v_fma_f32 v77, -v25, v172, v77
    v_mfma_f32_16x16x32_bf16 v[72:75], a[108:111], v[132:135], v[72:75]
    v_fma_f32 v89, -v179, v28, v89
    v_mfma_f32_16x16x32_bf16 v[84:87], a[112:115], v[132:135], v[84:87]
    ds_read_b64_tr_b16 v[124:125], v41 offset:12288
    v_fma_f32 v69, -v21, v174, v69
    v_mfma_f32_16x16x32_bf16 v[96:99], v[132:135], a[116:119], v[96:99]
    s_waitcnt lgkmcnt(7)
    ds_read_b64_tr_b16 v[126:127], v41 offset:12800
    v_fma_f32 v81, -v25, v174, v81
    v_mfma_f32_16x16x32_bf16 v[76:79], a[124:127], v[136:139], v[76:79]
    ds_read_b64_tr_b16 v[128:129], v40 offset:12288
    v_fma_f32 v93, -v183, v28, v93
    v_mfma_f32_16x16x32_bf16 v[88:91], v[136:139], a[128:131], v[88:91]
    ds_read_b64_tr_b16 v[130:131], v40 offset:12800
    v_fma_f32 v73, -v21, v176, v73
    v_mfma_f32_16x16x32_bf16 v[68:71], a[120:123], v[140:143], v[68:71]
    buffer_load_dwordx4 v4, s[4:7], s36 offen offset:3072 sc1 lds
    v_fma_f32 v85, -v25, v176, v85
    v_mfma_f32_16x16x32_bf16 v[80:83], a[124:127], v[140:143], v[80:83]
    s_add_u32 m0, s66, 49152
    ds_read_b64_tr_b16 v[132:133], v40 offset:28672
    v_fma_f32 v97, -v187, v28, v97
    v_mfma_f32_16x16x32_bf16 v[92:95], v[140:143], a[128:131], v[92:95]
    ds_read_b64_tr_b16 v[134:135], v40 offset:29184
    v_fma_f32 v78, -v26, v172, v78
    v_mfma_f32_16x16x32_bf16 v[72:75], a[120:123], v[144:147], v[72:75]
    v_fma_f32 v90, -v180, v28, v90
    v_mfma_f32_16x16x32_bf16 v[84:87], a[124:127], v[144:147], v[84:87]
    ds_read_b64_tr_b16 v[136:137], v41 offset:13312
    v_fma_f32 v70, -v22, v174, v70
    v_mfma_f32_16x16x32_bf16 v[96:99], v[144:147], a[128:131], v[96:99]
    s_waitcnt lgkmcnt(7)
    ds_read_b64_tr_b16 v[138:139], v41 offset:13824
    v_fma_f32 v82, -v26, v174, v82
    v_mfma_f32_16x16x32_bf16 v[76:79], a[136:139], v[148:151], v[76:79]
    ds_read_b64_tr_b16 v[140:141], v40 offset:13312
    v_fma_f32 v94, -v184, v28, v94
    v_mfma_f32_16x16x32_bf16 v[88:91], v[148:151], a[140:143], v[88:91]
    ds_read_b64_tr_b16 v[142:143], v40 offset:13824
    v_fma_f32 v74, -v22, v176, v74
    v_mfma_f32_16x16x32_bf16 v[68:71], a[132:135], v[152:155], v[68:71]
    buffer_load_dwordx4 v4, s[4:7], s38 offen offset:3072 sc1 lds
    v_fma_f32 v86, -v26, v176, v86
    v_mfma_f32_16x16x32_bf16 v[80:83], a[136:139], v[152:155], v[80:83]
    ds_read_b64_tr_b16 v[144:145], v40 offset:29696
    v_fma_f32 v98, -v188, v28, v98
    v_mfma_f32_16x16x32_bf16 v[92:95], v[152:155], a[140:143], v[92:95]
    ds_read_b64_tr_b16 v[146:147], v40 offset:30208
    v_fma_f32 v79, -v27, v172, v79
    v_mfma_f32_16x16x32_bf16 v[72:75], a[132:135], v[156:159], v[72:75]
    v_fma_f32 v91, -v181, v28, v91
    v_mfma_f32_16x16x32_bf16 v[84:87], a[136:139], v[156:159], v[84:87]
    ds_read_b64_tr_b16 v[148:149], v41 offset:14336
    v_fma_f32 v71, -v23, v174, v71
    v_mfma_f32_16x16x32_bf16 v[96:99], v[156:159], a[140:143], v[96:99]
    s_waitcnt lgkmcnt(7)
    ds_read_b64_tr_b16 v[150:151], v41 offset:14848
    v_fma_f32 v83, -v27, v174, v83
    v_mfma_f32_16x16x32_bf16 v[76:79], a[148:151], v[124:127], v[76:79]
    ds_read_b64_tr_b16 v[152:153], v40 offset:14336
    v_fma_f32 v95, -v185, v28, v95
    v_mfma_f32_16x16x32_bf16 v[88:91], v[124:127], a[152:155], v[88:91]
    ds_read_b64_tr_b16 v[154:155], v40 offset:14848
    v_fma_f32 v75, -v23, v176, v75
    v_mfma_f32_16x16x32_bf16 v[68:71], a[144:147], v[128:131], v[68:71]
    v_fma_f32 v87, -v27, v176, v87
    v_mfma_f32_16x16x32_bf16 v[80:83], a[148:151], v[128:131], v[80:83]
    ds_read_b64_tr_b16 v[156:157], v40 offset:30720
    v_fma_f32 v99, -v189, v28, v99
    v_mfma_f32_16x16x32_bf16 v[92:95], v[128:131], a[152:155], v[92:95]
    ds_read_b64_tr_b16 v[158:159], v40 offset:31232
    v_mfma_f32_16x16x32_bf16 v[72:75], a[144:147], v[132:135], v[72:75]
    ds_read_b64_tr_b16 v[240:241], v46 offset:0
    v_mfma_f32_16x16x32_bf16 v[84:87], a[148:151], v[132:135], v[84:87]
    ds_read_b64_tr_b16 v[124:125], v41 offset:15360
    v_mfma_f32_16x16x32_bf16 v[96:99], v[132:135], a[152:155], v[96:99]
    s_waitcnt lgkmcnt(8)
    ds_read_b64_tr_b16 v[126:127], v41 offset:15872
    v_mfma_f32_16x16x32_bf16 v[76:79], a[160:163], v[136:139], v[76:79]
    ds_read_b64_tr_b16 v[128:129], v40 offset:15360
    v_mfma_f32_16x16x32_bf16 v[88:91], v[136:139], a[164:167], v[88:91]
    ds_read_b64_tr_b16 v[130:131], v40 offset:15872
    v_mfma_f32_16x16x32_bf16 v[68:71], a[156:159], v[140:143], v[68:71]
    ds_read_b64_tr_b16 v[242:243], v46 offset:16384
    v_mfma_f32_16x16x32_bf16 v[80:83], a[160:163], v[140:143], v[80:83]
    ds_read_b64_tr_b16 v[132:133], v40 offset:31744
    v_mfma_f32_16x16x32_bf16 v[92:95], v[140:143], a[164:167], v[92:95]
    ds_read_b64_tr_b16 v[134:135], v40 offset:32256
    v_mfma_f32_16x16x32_bf16 v[72:75], a[156:159], v[144:147], v[72:75]
    v_mfma_f32_16x16x32_bf16 v[84:87], a[160:163], v[144:147], v[84:87]
    v_mfma_f32_16x16x32_bf16 v[96:99], v[144:147], a[164:167], v[96:99]
    s_waitcnt lgkmcnt(8)
    v_mfma_f32_16x16x32_bf16 v[76:79], a[172:175], v[148:151], v[76:79]
    ds_read_b64 v[190:191], v58 offset:0
    v_mfma_f32_16x16x32_bf16 v[88:91], v[148:151], a[176:179], v[88:91]
    ds_read_b64 v[192:193], v59 offset:0
    v_mfma_f32_16x16x32_bf16 v[68:71], a[168:171], v[152:155], v[68:71]
    ds_read_b64 v[194:195], v58 offset:256
    v_mfma_f32_16x16x32_bf16 v[80:83], a[172:175], v[152:155], v[80:83]
    ds_read_b64 v[196:197], v59 offset:256
    v_mfma_f32_16x16x32_bf16 v[92:95], v[152:155], a[176:179], v[92:95]
    ds_read_b64 v[198:199], v60 offset:0
    v_mfma_f32_16x16x32_bf16 v[72:75], a[168:171], v[156:159], v[72:75]
    ds_read_b64 v[200:201], v60 offset:32
    v_mfma_f32_16x16x32_bf16 v[84:87], a[172:175], v[156:159], v[84:87]
    ds_read_b64 v[202:203], v60 offset:64
    v_mfma_f32_16x16x32_bf16 v[96:99], v[156:159], a[176:179], v[96:99]
    s_waitcnt lgkmcnt(7)
    v_mfma_f32_16x16x32_bf16 v[76:79], a[184:187], v[124:127], v[76:79]
    v_mfma_f32_16x16x32_bf16 v[88:91], v[124:127], a[188:191], v[88:91]
    v_mfma_f32_16x16x32_bf16 v[68:71], a[180:183], v[128:131], v[68:71]
    v_mfma_f32_16x16x32_bf16 v[80:83], a[184:187], v[128:131], v[80:83]
    v_mfma_f32_16x16x32_bf16 v[92:95], v[128:131], a[188:191], v[92:95]
    v_mfma_f32_16x16x32_bf16 v[72:75], a[180:183], v[132:135], v[72:75]
    v_mfma_f32_16x16x32_bf16 v[84:87], a[184:187], v[132:135], v[84:87]
    v_mfma_f32_16x16x32_bf16 v[96:99], v[132:135], a[188:191], v[96:99]
    s_waitcnt vmcnt(6)
    ds_read_b64_tr_b16 v[124:125], v43 offset:16384
    ds_read_b64_tr_b16 v[126:127], v43 offset:16896
    ds_read_b64_tr_b16 v[128:129], v42 offset:32768
    ds_read_b64_tr_b16 v[130:131], v42 offset:33280
    ds_read_b64_tr_b16 v[132:133], v42 offset:49152
    ds_read_b64_tr_b16 v[134:135], v42 offset:49664
    ds_read_b64_tr_b16 v[136:137], v43 offset:17408
    ds_read_b64_tr_b16 v[138:139], v43 offset:17920
    ds_read_b64_tr_b16 v[140:141], v42 offset:33792
    ds_read_b64_tr_b16 v[142:143], v42 offset:34304
    ds_read_b64_tr_b16 v[144:145], v42 offset:50176
    ds_read_b64_tr_b16 v[146:147], v42 offset:50688
    v_cvt_pk_bf16_f32 v210, v76, v77
    v_cvt_pk_bf16_f32 v211, v78, v79
    v_cvt_pk_bf16_f32 v212, v80, v81
    v_cvt_pk_bf16_f32 v213, v82, v83
    v_cvt_pk_bf16_f32 v206, v68, v69
    v_cvt_pk_bf16_f32 v207, v70, v71
    v_cvt_pk_bf16_f32 v214, v84, v85
    v_cvt_pk_bf16_f32 v215, v86, v87
    v_cvt_pk_bf16_f32 v208, v72, v73
    v_cvt_pk_bf16_f32 v209, v74, v75
    s_waitcnt lgkmcnt(10)
    v_mfma_f32_16x16x32_bf16 v[112:115], v[16:19], v[124:127], 0
    s_waitcnt vmcnt(0)
    ds_read_b64_tr_b16 v[148:149], v43 offset:18432
    ds_read_b64_tr_b16 v[150:151], v43 offset:18944
    s_waitcnt lgkmcnt(10)
    v_mfma_f32_16x16x32_bf16 v[116:119], v[16:19], v[128:131], 0
    ds_read_b64_tr_b16 v[152:153], v42 offset:34816
    ds_read_b64_tr_b16 v[154:155], v42 offset:35328
    s_waitcnt lgkmcnt(10)
    v_mfma_f32_16x16x32_bf16 v[120:123], v[16:19], v[132:135], 0
    ds_read_b64_tr_b16 v[156:157], v42 offset:51200
    ds_read_b64_tr_b16 v[158:159], v42 offset:51712
    v_mfma_f32_16x16x32_bf16 v[100:103], v[124:127], v[124:127], 0
    ds_read_b64_tr_b16 v[178:179], v43 offset:19456
    ds_read_b64_tr_b16 v[180:181], v43 offset:19968
    v_mfma_f32_16x16x32_bf16 v[104:107], v[128:131], v[128:131], 0
    ds_read_b64_tr_b16 v[182:183], v42 offset:35840
    ds_read_b64_tr_b16 v[184:185], v42 offset:36352
    v_mfma_f32_16x16x32_bf16 v[108:111], v[132:135], v[132:135], 0
    s_waitcnt lgkmcnt(10)
    ds_read_b64_tr_b16 v[186:187], v42 offset:52224
    ds_read_b64_tr_b16 v[188:189], v42 offset:52736
    v_mfma_f32_16x16x32_bf16 v[112:115], v[16:19], v[136:139], v[112:115]
    v_cvt_pk_bf16_f32 v216, v88, v89
    v_cvt_pk_bf16_f32 v217, v90, v91
    v_mfma_f32_16x16x32_bf16 v[116:119], v[16:19], v[140:143], v[116:119]
    v_cvt_pk_bf16_f32 v218, v92, v93
    v_cvt_pk_bf16_f32 v219, v94, v95
    v_mfma_f32_16x16x32_bf16 v[120:123], v[16:19], v[144:147], v[120:123]
    s_waitcnt lgkmcnt(6)
    v_cvt_pk_bf16_f32 v220, v96, v97
    v_cvt_pk_bf16_f32 v221, v98, v99
    v_mfma_f32_16x16x32_bf16 v[112:115], v[16:19], v[148:151], v[112:115]
    v_mul_f32 v204, s30, v175
    v_mul_f32 v205, s30, v177
    v_mfma_f32_16x16x16_bf16 v[232:235], v[210:211], v[206:207], v[36:39]
    v_mfma_f32_16x16x16_bf16 v[224:227], v[212:213], v[206:207], 0
    v_mfma_f32_16x16x16_bf16 v[236:239], v[212:213], v[208:209], 0
    v_mfma_f32_16x16x16_bf16 v[228:231], v[214:215], v[208:209], 0
    s_add_u32 s41, s73, 0
    v_mfma_f32_16x16x32_bf16 v[116:119], v[16:19], v[152:155], v[116:119]
    s_nop 2
    v_cndmask_b32 v232, v232, v233, s[54:55]
    v_cndmask_b32 v234, v234, v235, s[54:55]
    v_mfma_f32_16x16x32_bf16 v[120:123], v[16:19], v[156:159], v[120:123]
    s_waitcnt lgkmcnt(0)
    v_cndmask_b32 v224, v224, v225, s[54:55]
    v_cndmask_b32 v226, v226, v227, s[54:55]
    v_mfma_f32_16x16x32_bf16 v[112:115], v[16:19], v[178:181], v[112:115]
    v_cndmask_b32 v236, v236, v237, s[54:55]
    v_cndmask_b32 v238, v238, v239, s[54:55]
    v_mfma_f32_16x16x32_bf16 v[116:119], v[16:19], v[182:185], v[116:119]
    v_cndmask_b32 v228, v228, v229, s[54:55]
    v_cndmask_b32 v230, v230, v231, s[54:55]
    v_mfma_f32_16x16x32_bf16 v[120:123], v[16:19], v[186:189], v[120:123]
    v_cndmask_b32 v224, v232, v224, s[56:57]
    v_cndmask_b32 v225, v234, v226, s[58:59]
    v_mfma_f32_16x16x32_bf16 v[100:103], v[136:139], v[136:139], v[100:103]
    v_cndmask_b32 v228, v236, v228, s[56:57]
    v_cndmask_b32 v229, v238, v230, s[58:59]
    v_mfma_f32_16x16x32_bf16 v[104:107], v[140:143], v[140:143], v[104:107]
    v_mul_f32 v224, v224, v190
    v_mul_f32 v225, v225, v192
    v_mfma_f32_16x16x32_bf16 v[108:111], v[144:147], v[144:147], v[108:111]
    v_add_f32 v252, v112, v116
    v_cmp_u_f32 vcc, v252, v120
    v_mfma_f32_16x16x32_bf16 v[100:103], v[148:151], v[148:151], v[100:103]
    s_cbranch_vccnz sr11
so11:
    v_mul_f32 v228, v228, v194
    v_mfma_f32_16x16x32_bf16 v[104:107], v[152:155], v[152:155], v[104:107]
    s_barrier
    ds_read_b64_tr_b16 v[124:125], v41 offset:16384
    ds_read_b64_tr_b16 v[126:127], v41 offset:16896
    v_mfma_f32_16x16x32_bf16 v[108:111], v[156:159], v[156:159], v[108:111]
    ds_read_b64_tr_b16 v[128:129], v40 offset:32768
    ds_read_b64_tr_b16 v[130:131], v40 offset:33280
    v_mfma_f32_16x16x32_bf16 v[100:103], v[178:181], v[178:181], v[100:103]
    ds_read_b64_tr_b16 v[132:133], v40 offset:49152
    ds_read_b64_tr_b16 v[134:135], v40 offset:49664
    v_mfma_f32_16x16x32_bf16 v[104:107], v[182:185], v[182:185], v[104:107]
    ds_read_b64_tr_b16 v[136:137], v41 offset:17408
    ds_read_b64_tr_b16 v[138:139], v41 offset:17920
    v_mfma_f32_16x16x32_bf16 v[108:111], v[186:189], v[186:189], v[108:111]
    ds_read_b64_tr_b16 v[140:141], v40 offset:33792
    ds_read_b64_tr_b16 v[142:143], v40 offset:34304
    ds_read_b64_tr_b16 v[144:145], v40 offset:50176
    ds_read_b64_tr_b16 v[146:147], v40 offset:50688
    s_waitcnt lgkmcnt(10)
    v_mfma_f32_16x16x32_bf16 v[76:79], a[4:7], v[124:127], 0
    ds_read_b64_tr_b16 v[148:149], v41 offset:18432
    v_mul_f32 v229, v229, v196
    v_mfma_f32_16x16x32_bf16 v[88:91], v[124:127], a[8:11], 0
    ds_read_b64_tr_b16 v[150:151], v41 offset:18944
    v_max_f32 v222, v224, v225
    s_waitcnt lgkmcnt(10)
    v_mfma_f32_16x16x32_bf16 v[68:71], a[0:3], v[128:131], 0
    ds_read_b64_tr_b16 v[152:153], v40 offset:34816
    v_max_f32 v223, v228, v229
    v_mfma_f32_16x16x32_bf16 v[80:83], a[4:7], v[128:131], 0
    ds_read_b64_tr_b16 v[154:155], v40 offset:35328
    v_permlane16_swap_b32 v222, v223
    v_mfma_f32_16x16x32_bf16 v[92:95], v[128:131], a[8:11], 0
    ds_read_b64_tr_b16 v[156:157], v40 offset:51200
    v_max_f32 v222, v222, v223
    s_waitcnt lgkmcnt(11)
    v_mfma_f32_16x16x32_bf16 v[72:75], a[0:3], v[132:135], 0
iw6:
    s_cbranch_execz iw_back
    ds_read_b64_tr_b16 v[158:159], v40 offset:51712
    v_mov_b32 v223, v222
    v_mfma_f32_16x16x32_bf16 v[84:87], a[4:7], v[132:135], 0
    ds_read_b64_tr_b16 v[124:125], v41 offset:19456
    v_permlane32_swap_b32 v222, v223
    v_mfma_f32_16x16x32_bf16 v[96:99], v[132:135], a[8:11], 0
    s_waitcnt lgkmcnt(7)
    ds_read_b64_tr_b16 v[126:127], v41 offset:19968
    v_max_f32 v222, v222, v223
    v_mfma_f32_16x16x32_bf16 v[76:79], a[16:19], v[136:139], v[76:79]
    ds_read_b64_tr_b16 v[128:129], v40 offset:35840
    v_mov_b32 v223, v222
    v_mfma_f32_16x16x32_bf16 v[88:91], v[136:139], a[20:23], v[88:91]
    ds_read_b64_tr_b16 v[130:131], v40 offset:36352
    v_permlane16_swap_b32 v222, v223
    v_mfma_f32_16x16x32_bf16 v[68:71], a[12:15], v[140:143], v[68:71]
    v_sub_f32 v224, v224, v222
    v_sub_f32 v225, v225, v222
    v_mfma_f32_16x16x32_bf16 v[80:83], a[16:19], v[140:143], v[80:83]
    ds_read_b64_tr_b16 v[132:133], v40 offset:52224
    v_sub_f32 v228, v228, v223
    v_mfma_f32_16x16x32_bf16 v[92:95], v[140:143], a[20:23], v[92:95]
    ds_read_b64_tr_b16 v[134:135], v40 offset:52736
    v_sub_f32 v229, v229, v223
    v_mfma_f32_16x16x32_bf16 v[72:75], a[12:15], v[144:147], v[72:75]
    v_fma_f32 v224, v224, v204, -v191
    v_fma_f32 v225, v225, v204, -v193
    v_mfma_f32_16x16x32_bf16 v[84:87], a[16:19], v[144:147], v[84:87]
    ds_read_b64_tr_b16 v[136:137], v41 offset:20480
    v_fma_f32 v228, v228, v205, -v195
    v_mfma_f32_16x16x32_bf16 v[96:99], v[144:147], a[20:23], v[96:99]
    s_waitcnt lgkmcnt(7)
    ds_read_b64_tr_b16 v[138:139], v41 offset:20992
    v_fma_f32 v229, v229, v205, -v197
    v_mfma_f32_16x16x32_bf16 v[76:79], a[28:31], v[148:151], v[76:79]
    ds_read_b64_tr_b16 v[140:141], v40 offset:36864
    v_exp_f32 v224, v224
    v_mfma_f32_16x16x32_bf16 v[88:91], v[148:151], a[32:35], v[88:91]
    ds_read_b64_tr_b16 v[142:143], v40 offset:37376
    v_exp_f32 v225, v225
    v_mfma_f32_16x16x32_bf16 v[68:71], a[24:27], v[152:155], v[68:71]
    v_exp_f32 v228, v228
    v_exp_f32 v229, v229
    v_mfma_f32_16x16x32_bf16 v[80:83], a[28:31], v[152:155], v[80:83]
    ds_read_b64_tr_b16 v[144:145], v40 offset:53248
    v_cvt_pk_bf16_f32 v224, v224, v224
    v_mfma_f32_16x16x32_bf16 v[92:95], v[152:155], a[32:35], v[92:95]
    ds_read_b64_tr_b16 v[146:147], v40 offset:53760
    v_cvt_pk_bf16_f32 v225, v225, v225
    v_mfma_f32_16x16x32_bf16 v[72:75], a[24:27], v[156:159], v[72:75]
    v_cvt_pk_bf16_f32 v228, v228, v228
    v_cvt_pk_bf16_f32 v229, v229, v229
    v_mfma_f32_16x16x32_bf16 v[84:87], a[28:31], v[156:159], v[84:87]
    ds_read_b64_tr_b16 v[148:149], v41 offset:21504
    v_and_b32 v232, v224, v32
    v_mfma_f32_16x16x32_bf16 v[96:99], v[156:159], a[32:35], v[96:99]
    s_waitcnt lgkmcnt(7)
    ds_read_b64_tr_b16 v[150:151], v41 offset:22016
    v_and_b32 v233, v225, v33
    v_mfma_f32_16x16x32_bf16 v[76:79], a[40:43], v[124:127], v[76:79]
    ds_read_b64_tr_b16 v[152:153], v40 offset:37888
    v_and_b32 v234, v224, v34
    v_mfma_f32_16x16x32_bf16 v[88:91], v[124:127], a[44:47], v[88:91]
    ds_read_b64_tr_b16 v[154:155], v40 offset:38400
    v_and_b32 v235, v225, v35
    v_mfma_f32_16x16x32_bf16 v[68:71], a[36:39], v[128:131], v[68:71]
    v_and_b32 v236, v228, v32
    v_and_b32 v237, v229, v33
    v_mfma_f32_16x16x32_bf16 v[80:83], a[40:43], v[128:131], v[80:83]
    ds_read_b64_tr_b16 v[156:157], v40 offset:54272
    v_and_b32 v238, v228, v34
    v_mfma_f32_16x16x32_bf16 v[92:95], v[128:131], a[44:47], v[92:95]
    ds_read_b64_tr_b16 v[158:159], v40 offset:54784
    v_and_b32 v239, v229, v35
    v_mfma_f32_16x16x32_bf16 v[160:163], v[198:201], v[232:235], 0
    v_cndmask_b32 v113, v100, v101, s[48:49]
    v_mfma_f32_16x16x32_bf16 v[164:167], v[200:203], v[236:239], 0
    v_cndmask_b32 v113, v113, v102, s[50:51]
    v_mfma_f32_16x16x32_bf16 v[178:181], v[216:219], v[232:235], 0
    v_cndmask_b32 v113, v113, v103, s[52:53]
    v_mfma_f32_16x16x32_bf16 v[182:185], v[218:221], v[236:239], 0
    v_cndmask_b32 v117, v104, v105, s[48:49]
    v_mfma_f32_16x16x32_bf16 v[72:75], a[36:39], v[132:135], v[72:75]
    v_rcp_f32 v160, v160
    v_cndmask_b32 v117, v117, v106, s[50:51]
    v_mfma_f32_16x16x32_bf16 v[84:87], a[40:43], v[132:135], v[84:87]
    ds_read_b64_tr_b16 v[124:125], v41 offset:22528
    v_rcp_f32 v164, v164
    v_mfma_f32_16x16x32_bf16 v[96:99], v[132:135], a[44:47], v[96:99]
    s_waitcnt lgkmcnt(7)
    ds_read_b64_tr_b16 v[126:127], v41 offset:23040
    v_mul_f32 v178, v178, v160
    v_mfma_f32_16x16x32_bf16 v[76:79], a[52:55], v[136:139], v[76:79]
    ds_read_b64_tr_b16 v[128:129], v40 offset:38912
    v_mul_f32 v179, v179, v160
    v_mfma_f32_16x16x32_bf16 v[88:91], v[136:139], a[56:59], v[88:91]
    ds_read_b64_tr_b16 v[130:131], v40 offset:39424
    v_mul_f32 v180, v180, v160
    v_mfma_f32_16x16x32_bf16 v[68:71], a[48:51], v[140:143], v[68:71]
    v_mul_f32 v181, v181, v160
    v_mul_f32 v182, v182, v164
    v_mfma_f32_16x16x32_bf16 v[80:83], a[52:55], v[140:143], v[80:83]
    ds_read_b64_tr_b16 v[132:133], v40 offset:55296
    v_mul_f32 v183, v183, v164
    v_mfma_f32_16x16x32_bf16 v[92:95], v[140:143], a[56:59], v[92:95]
    ds_read_b64_tr_b16 v[134:135], v40 offset:55808
    v_mul_f32 v184, v184, v164
    v_mfma_f32_16x16x32_bf16 v[72:75], a[48:51], v[144:147], v[72:75]
    v_mul_f32 v185, v185, v164
    v_cvt_pk_bf16_f32 v224, v178, v179
    v_mfma_f32_16x16x32_bf16 v[84:87], a[52:55], v[144:147], v[84:87]
    ds_read_b64_tr_b16 v[136:137], v41 offset:23552
    v_cvt_pk_bf16_f32 v225, v180, v181
    v_mfma_f32_16x16x32_bf16 v[96:99], v[144:147], a[56:59], v[96:99]
    s_waitcnt lgkmcnt(7)
    ds_read_b64_tr_b16 v[138:139], v41 offset:24064
    v_cvt_pk_bf16_f32 v226, v182, v183
    v_mfma_f32_16x16x32_bf16 v[76:79], a[64:67], v[148:151], v[76:79]
    ds_read_b64_tr_b16 v[140:141], v40 offset:39936
    v_cvt_pk_bf16_f32 v227, v184, v185
    v_mfma_f32_16x16x32_bf16 v[88:91], v[148:151], a[68:71], v[88:91]
    ds_read_b64_tr_b16 v[142:143], v40 offset:40448
    v_permlane16_swap_b32 v224, v226
    v_mfma_f32_16x16x32_bf16 v[68:71], a[60:63], v[152:155], v[68:71]
    v_permlane16_swap_b32 v225, v227
    v_cndmask_b32 v117, v117, v107, s[52:53]
    v_mfma_f32_16x16x32_bf16 v[80:83], a[64:67], v[152:155], v[80:83]
    ds_read_b64_tr_b16 v[144:145], v40 offset:56320
    buffer_store_dwordx4 v[224:227], v44, s[4:7], s41 offen sc1
    v_mfma_f32_16x16x32_bf16 v[92:95], v[152:155], a[68:71], v[92:95]
    ds_read_b64_tr_b16 v[146:147], v40 offset:56832
    v_cndmask_b32 v121, v108, v109, s[48:49]
    v_mfma_f32_16x16x32_bf16 v[72:75], a[60:63], v[156:159], v[72:75]
    v_cndmask_b32 v121, v121, v110, s[50:51]
    v_mfma_f32_16x16x32_bf16 v[84:87], a[64:67], v[156:159], v[84:87]
    ds_read_b64_tr_b16 v[148:149], v41 offset:24576
    v_cndmask_b32 v121, v121, v111, s[52:53]
    v_mfma_f32_16x16x32_bf16 v[96:99], v[156:159], a[68:71], v[96:99]
    s_waitcnt lgkmcnt(7)
    ds_read_b64_tr_b16 v[150:151], v41 offset:25088
    ds_write_b64 v52, v[112:113] offset:0
    v_mfma_f32_16x16x32_bf16 v[76:79], a[76:79], v[124:127], v[76:79]
    ds_read_b64_tr_b16 v[152:153], v40 offset:40960
    ds_write_b64 v52, v[116:117] offset:128
    v_mfma_f32_16x16x32_bf16 v[88:91], v[124:127], a[80:83], v[88:91]
    ds_read_b64_tr_b16 v[154:155], v40 offset:41472
    ds_write_b64 v52, v[120:121] offset:256
    v_mfma_f32_16x16x32_bf16 v[68:71], a[72:75], v[128:131], v[68:71]
    v_mfma_f32_16x16x32_bf16 v[80:83], a[76:79], v[128:131], v[80:83]
    ds_read_b64_tr_b16 v[156:157], v40 offset:57344
    v_mfma_f32_16x16x32_bf16 v[92:95], v[128:131], a[80:83], v[92:95]
    s_waitcnt lgkmcnt(1)
    s_barrier
    ds_read_b64_tr_b16 v[158:159], v40 offset:57856
    v_mfma_f32_16x16x32_bf16 v[72:75], a[72:75], v[132:135], v[72:75]
    ds_read_b64 v[160:161], v53 offset:0
    v_mfma_f32_16x16x32_bf16 v[84:87], a[76:79], v[132:135], v[84:87]
    ds_read_b64_tr_b16 v[124:125], v41 offset:25600
    ds_read_b64 v[162:163], v53 offset:512
    v_mfma_f32_16x16x32_bf16 v[96:99], v[132:135], a[80:83], v[96:99]
    ds_read_b64_tr_b16 v[126:127], v41 offset:26112
    ds_read_b64 v[164:165], v53 offset:1024
    v_mfma_f32_16x16x32_bf16 v[76:79], a[88:91], v[136:139], v[76:79]
    ds_read_b64_tr_b16 v[128:129], v40 offset:41984
    ds_read_b64 v[166:167], v53 offset:1536
    v_mfma_f32_16x16x32_bf16 v[88:91], v[136:139], a[92:95], v[88:91]
    ds_read_b64_tr_b16 v[130:131], v40 offset:42496
    v_mfma_f32_16x16x32_bf16 v[68:71], a[84:87], v[140:143], v[68:71]
    v_mfma_f32_16x16x32_bf16 v[80:83], a[88:91], v[140:143], v[80:83]
    ds_read_b64_tr_b16 v[132:133], v40 offset:58368
    v_mfma_f32_16x16x32_bf16 v[92:95], v[140:143], a[92:95], v[92:95]
    s_waitcnt lgkmcnt(2)
    ds_read_b64_tr_b16 v[134:135], v40 offset:58880
    v_add_f32 v160, v160, v162
    v_mfma_f32_16x16x32_bf16 v[72:75], a[84:87], v[144:147], v[72:75]
    v_add_f32 v161, v161, v163
    v_mfma_f32_16x16x32_bf16 v[84:87], a[88:91], v[144:147], v[84:87]
    ds_read_b64_tr_b16 v[136:137], v41 offset:26624
    v_add_f32 v164, v164, v166
    v_mfma_f32_16x16x32_bf16 v[96:99], v[144:147], a[92:95], v[96:99]
    ds_read_b64_tr_b16 v[138:139], v41 offset:27136
    v_add_f32 v165, v165, v167
    v_mfma_f32_16x16x32_bf16 v[76:79], a[100:103], v[148:151], v[76:79]
    ds_read_b64_tr_b16 v[140:141], v40 offset:43008
    v_add_f32 v160, v160, v164
    v_mfma_f32_16x16x32_bf16 v[88:91], v[148:151], a[104:107], v[88:91]
    ds_read_b64_tr_b16 v[142:143], v40 offset:43520
    v_add_f32 v161, v161, v165
    v_mfma_f32_16x16x32_bf16 v[68:71], a[96:99], v[152:155], v[68:71]
    v_mul_f32 v170, s28, v160
    v_mfma_f32_16x16x32_bf16 v[80:83], a[100:103], v[152:155], v[80:83]
    ds_read_b64_tr_b16 v[144:145], v40 offset:59392
    v_mul_f32 v161, s28, v161
    v_mfma_f32_16x16x32_bf16 v[92:95], v[152:155], a[104:107], v[92:95]
    ds_read_b64_tr_b16 v[146:147], v40 offset:59904
    v_fma_f32 v161, -v170, v170, v161
    v_mfma_f32_16x16x32_bf16 v[72:75], a[96:99], v[156:159], v[72:75]
    v_max_f32 v161, 0, v161
    v_mfma_f32_16x16x32_bf16 v[84:87], a[100:103], v[156:159], v[84:87]
    ds_read_b64_tr_b16 v[148:149], v41 offset:27648
    v_add_f32 v161, s29, v161
    v_mfma_f32_16x16x32_bf16 v[96:99], v[156:159], a[104:107], v[96:99]
    s_waitcnt lgkmcnt(7)
    ds_read_b64_tr_b16 v[150:151], v41 offset:28160
    v_sqrt_f32 v161, v161
    v_mfma_f32_16x16x32_bf16 v[76:79], a[112:115], v[124:127], v[76:79]
    ds_read_b64_tr_b16 v[152:153], v40 offset:44032
    v_cvt_pk_bf16_f32 v162, v161, v161
    v_mfma_f32_16x16x32_bf16 v[88:91], v[124:127], a[116:119], v[88:91]
    ds_read_b64_tr_b16 v[154:155], v40 offset:44544
    v_and_b32 v161, 0xffff0000, v162
    v_mfma_f32_16x16x32_bf16 v[68:71], a[108:111], v[128:131], v[68:71]
    v_rcp_f32 v168, v161
    v_mfma_f32_16x16x32_bf16 v[80:83], a[112:115], v[128:131], v[80:83]
    ds_read_b64_tr_b16 v[156:157], v40 offset:60416
    v_log_f32 v169, v161
    v_mfma_f32_16x16x32_bf16 v[92:95], v[128:131], a[116:119], v[92:95]
    ds_read_b64_tr_b16 v[158:159], v40 offset:60928
    v_mov_b32 v171, v168
    v_mfma_f32_16x16x32_bf16 v[72:75], a[108:111], v[132:135], v[72:75]
    ds_write_b128 v54, v[168:171]
    v_mfma_f32_16x16x32_bf16 v[84:87], a[112:115], v[132:135], v[84:87]
    ds_read_b64_tr_b16 v[124:125], v41 offset:28672
    ds_write_b16 v55, v162
    v_mfma_f32_16x16x32_bf16 v[96:99], v[132:135], a[116:119], v[96:99]
    s_waitcnt lgkmcnt(9)
    ds_read_b64_tr_b16 v[126:127], v41 offset:29184
    ds_read_b64 v[172:173], v56 offset:8
    v_mfma_f32_16x16x32_bf16 v[76:79], a[124:127], v[136:139], v[76:79]
    ds_read_b64_tr_b16 v[128:129], v40 offset:45056
    ds_read_b64 v[174:175], v56 offset:264
    v_mfma_f32_16x16x32_bf16 v[88:91], v[136:139], a[128:131], v[88:91]
    ds_read_b64_tr_b16 v[130:131], v40 offset:45568
    ds_read_b64 v[176:177], v56 offset:520
    v_mfma_f32_16x16x32_bf16 v[68:71], a[120:123], v[140:143], v[68:71]
    ds_read2_b32 v[178:179], v57 offset0:2 offset1:6
    v_mfma_f32_16x16x32_bf16 v[80:83], a[124:127], v[140:143], v[80:83]
    ds_read_b64_tr_b16 v[132:133], v40 offset:61440
    ds_read2_b32 v[180:181], v57 offset0:10 offset1:14
    v_mfma_f32_16x16x32_bf16 v[92:95], v[140:143], a[128:131], v[92:95]
    ds_read_b64_tr_b16 v[134:135], v40 offset:61952
    ds_read2_b32 v[182:183], v57 offset0:66 offset1:70
    v_mfma_f32_16x16x32_bf16 v[72:75], a[120:123], v[144:147], v[72:75]
    ds_read2_b32 v[184:185], v57 offset0:74 offset1:78
    v_mfma_f32_16x16x32_bf16 v[84:87], a[124:127], v[144:147], v[84:87]
    ds_read_b64_tr_b16 v[136:137], v41 offset:29696
    ds_read2_b32 v[186:187], v57 offset0:130 offset1:134
    v_mfma_f32_16x16x32_bf16 v[96:99], v[144:147], a[128:131], v[96:99]
    s_waitcnt lgkmcnt(15)
    ds_read_b64_tr_b16 v[138:139], v41 offset:30208
    ds_read2_b32 v[188:189], v57 offset0:138 offset1:142
    v_mfma_f32_16x16x32_bf16 v[76:79], a[136:139], v[148:151], v[76:79]
    ds_read_b64_tr_b16 v[140:141], v40 offset:46080
    v_mfma_f32_16x16x32_bf16 v[88:91], v[148:151], a[140:143], v[88:91]
    ds_read_b64_tr_b16 v[142:143], v40 offset:46592
    v_mfma_f32_16x16x32_bf16 v[68:71], a[132:135], v[152:155], v[68:71]
    v_mfma_f32_16x16x32_bf16 v[80:83], a[136:139], v[152:155], v[80:83]
    s_waitcnt lgkmcnt(2)
    ds_read_b64_tr_b16 v[144:145], v40 offset:62464
    v_mfma_f32_16x16x32_bf16 v[92:95], v[152:155], a[140:143], v[92:95]
    ds_read_b64_tr_b16 v[146:147], v40 offset:62976
    v_fma_f32 v76, -v24, v172, v76
    v_mfma_f32_16x16x32_bf16 v[72:75], a[132:135], v[156:159], v[72:75]
    v_fma_f32 v88, -v178, v28, v88
    v_mfma_f32_16x16x32_bf16 v[84:87], a[136:139], v[156:159], v[84:87]
    ds_read_b64_tr_b16 v[148:149], v41 offset:30720
    v_fma_f32 v68, -v20, v174, v68
    v_mfma_f32_16x16x32_bf16 v[96:99], v[156:159], a[140:143], v[96:99]
    ds_read_b64_tr_b16 v[150:151], v41 offset:31232
    v_fma_f32 v80, -v24, v174, v80
    v_mfma_f32_16x16x32_bf16 v[76:79], a[148:151], v[124:127], v[76:79]
    ds_read_b64_tr_b16 v[152:153], v40 offset:47104
    v_fma_f32 v92, -v182, v28, v92
    v_mfma_f32_16x16x32_bf16 v[88:91], v[124:127], a[152:155], v[88:91]
    ds_read_b64_tr_b16 v[154:155], v40 offset:47616
    v_fma_f32 v72, -v20, v176, v72
    v_mfma_f32_16x16x32_bf16 v[68:71], a[144:147], v[128:131], v[68:71]
    v_fma_f32 v84, -v24, v176, v84
    v_mfma_f32_16x16x32_bf16 v[80:83], a[148:151], v[128:131], v[80:83]
    ds_read_b64_tr_b16 v[156:157], v40 offset:63488
    v_fma_f32 v96, -v186, v28, v96
    v_mfma_f32_16x16x32_bf16 v[92:95], v[128:131], a[152:155], v[92:95]
    s_add_u32 s40, s74, 0
    ds_read_b64_tr_b16 v[158:159], v40 offset:64000
    v_fma_f32 v77, -v25, v172, v77
    v_mfma_f32_16x16x32_bf16 v[72:75], a[144:147], v[132:135], v[72:75]
    s_add_u32 m0, s66, 0
    ds_read_b64_tr_b16 v[244:245], v46 offset:32768
    v_fma_f32 v89, -v179, v28, v89
    v_mfma_f32_16x16x32_bf16 v[84:87], a[148:151], v[132:135], v[84:87]
    ds_read_b64_tr_b16 v[124:125], v41 offset:31744
    v_fma_f32 v69, -v21, v174, v69
    v_mfma_f32_16x16x32_bf16 v[96:99], v[132:135], a[152:155], v[96:99]
    s_waitcnt lgkmcnt(8)
    ds_read_b64_tr_b16 v[126:127], v41 offset:32256
    v_fma_f32 v81, -v25, v174, v81
    v_mfma_f32_16x16x32_bf16 v[76:79], a[160:163], v[136:139], v[76:79]
    ds_read_b64_tr_b16 v[128:129], v40 offset:48128
    v_fma_f32 v93, -v183, v28, v93
    v_mfma_f32_16x16x32_bf16 v[88:91], v[136:139], a[164:167], v[88:91]
    ds_read_b64_tr_b16 v[130:131], v40 offset:48640
    v_fma_f32 v73, -v21, v176, v73
    v_mfma_f32_16x16x32_bf16 v[68:71], a[156:159], v[140:143], v[68:71]
    buffer_load_dwordx4 v4, s[4:7], s40 offen offset:0 sc1 lds
    v_fma_f32 v85, -v25, v176, v85
    v_mfma_f32_16x16x32_bf16 v[80:83], a[160:163], v[140:143], v[80:83]
    ds_read_b64_tr_b16 v[132:133], v40 offset:64512
    v_fma_f32 v97, -v187, v28, v97
    v_mfma_f32_16x16x32_bf16 v[92:95], v[140:143], a[164:167], v[92:95]
    ds_read_b64_tr_b16 v[134:135], v40 offset:65024
    v_fma_f32 v78, -v26, v172, v78
    v_mfma_f32_16x16x32_bf16 v[72:75], a[156:159], v[144:147], v[72:75]
    buffer_load_dwordx4 v4, s[4:7], s40 offen offset:1024 sc1 lds
    v_fma_f32 v90, -v180, v28, v90
    v_mfma_f32_16x16x32_bf16 v[84:87], a[160:163], v[144:147], v[84:87]
    ds_read_b64_tr_b16 v[246:247], v46 offset:49152
    v_fma_f32 v70, -v22, v174, v70
    v_mfma_f32_16x16x32_bf16 v[96:99], v[144:147], a[164:167], v[96:99]
    s_waitcnt lgkmcnt(8)
    v_fma_f32 v82, -v26, v174, v82
    v_mfma_f32_16x16x32_bf16 v[76:79], a[172:175], v[148:151], v[76:79]
    buffer_load_dwordx4 v4, s[4:7], s40 offen offset:2048 sc1 lds
    v_fma_f32 v94, -v184, v28, v94
    v_mfma_f32_16x16x32_bf16 v[88:91], v[148:151], a[176:179], v[88:91]
    ds_read_b64 v[190:191], v58 offset:0
    v_fma_f32 v74, -v22, v176, v74
    v_mfma_f32_16x16x32_bf16 v[68:71], a[168:171], v[152:155], v[68:71]
    ds_read_b64 v[192:193], v59 offset:0
    v_fma_f32 v86, -v26, v176, v86
    v_mfma_f32_16x16x32_bf16 v[80:83], a[172:175], v[152:155], v[80:83]
    buffer_load_dwordx4 v4, s[4:7], s40 offen offset:3072 sc1 lds
    v_fma_f32 v98, -v188, v28, v98
    v_mfma_f32_16x16x32_bf16 v[92:95], v[152:155], a[176:179], v[92:95]
    s_add_u32 s40, s74, 16384
    s_add_u32 m0, s66, 16384
    v_fma_f32 v79, -v27, v172, v79
    v_mfma_f32_16x16x32_bf16 v[72:75], a[168:171], v[156:159], v[72:75]
    ds_read_b64 v[194:195], v58 offset:256
    v_fma_f32 v91, -v181, v28, v91
    v_mfma_f32_16x16x32_bf16 v[84:87], a[172:175], v[156:159], v[84:87]
    buffer_load_dwordx4 v4, s[4:7], s40 offen offset:0 sc1 lds
    v_fma_f32 v71, -v23, v174, v71
    v_mfma_f32_16x16x32_bf16 v[96:99], v[156:159], a[176:179], v[96:99]
    s_waitcnt lgkmcnt(4)
    ds_read_b64 v[196:197], v59 offset:256
    v_fma_f32 v83, -v27, v174, v83
    v_mfma_f32_16x16x32_bf16 v[76:79], a[184:187], v[124:127], v[76:79]
    ds_read_b64 v[198:199], v60 offset:0
    v_fma_f32 v95, -v185, v28, v95
    v_mfma_f32_16x16x32_bf16 v[88:91], v[124:127], a[188:191], v[88:91]
    buffer_load_dwordx4 v4, s[4:7], s40 offen offset:1024 sc1 lds
    v_fma_f32 v75, -v23, v176, v75
    v_mfma_f32_16x16x32_bf16 v[68:71], a[180:183], v[128:131], v[68:71]
    ds_read_b64 v[200:201], v60 offset:32
    v_fma_f32 v87, -v27, v176, v87
    v_mfma_f32_16x16x32_bf16 v[80:83], a[184:187], v[128:131], v[80:83]
    ds_read_b64 v[202:203], v60 offset:64
    v_fma_f32 v99, -v189, v28, v99
    v_mfma_f32_16x16x32_bf16 v[92:95], v[128:131], a[188:191], v[92:95]
    buffer_load_dwordx4 v4, s[4:7], s40 offen offset:2048 sc1 lds
    v_mfma_f32_16x16x32_bf16 v[72:75], a[180:183], v[132:135], v[72:75]
    v_mfma_f32_16x16x32_bf16 v[84:87], a[184:187], v[132:135], v[84:87]
    v_mfma_f32_16x16x32_bf16 v[96:99], v[132:135], a[188:191], v[96:99]
    buffer_load_dwordx4 v4, s[4:7], s40 offen offset:3072 sc1 lds
    v_cvt_pk_bf16_f32 v210, v76, v77
    v_cvt_pk_bf16_f32 v211, v78, v79
    v_cvt_pk_bf16_f32 v212, v80, v81
    v_cvt_pk_bf16_f32 v213, v82, v83
    v_cvt_pk_bf16_f32 v206, v68, v69
    v_cvt_pk_bf16_f32 v207, v70, v71
    v_cvt_pk_bf16_f32 v214, v84, v85
    v_cvt_pk_bf16_f32 v215, v86, v87
    v_cvt_pk_bf16_f32 v208, v72, v73
    v_cvt_pk_bf16_f32 v209, v74, v75
    v_mfma_f32_16x16x16_bf16 v[232:235], v[210:211], v[206:207], 0
    v_cvt_pk_bf16_f32 v216, v88, v89
    v_cvt_pk_bf16_f32 v217, v90, v91
    v_mfma_f32_16x16x16_bf16 v[224:227], v[212:213], v[206:207], 0
    v_cvt_pk_bf16_f32 v218, v92, v93
    v_cvt_pk_bf16_f32 v219, v94, v95
    v_mfma_f32_16x16x16_bf16 v[236:239], v[212:213], v[208:209], 0
    v_cvt_pk_bf16_f32 v220, v96, v97
    v_cvt_pk_bf16_f32 v221, v98, v99
    v_mfma_f32_16x16x16_bf16 v[228:231], v[214:215], v[208:209], 0
    v_mul_f32 v204, s30, v175
    v_mul_f32 v205, s30, v177
    s_add_u32 s41, s73, 1048576
    v_cndmask_b32 v232, v232, v233, s[54:55]
    v_cndmask_b32 v234, v234, v235, s[54:55]
    v_cndmask_b32 v224, v224, v225, s[54:55]
    v_cndmask_b32 v226, v226, v227, s[54:55]
    v_cndmask_b32 v236, v236, v237, s[54:55]
    v_cndmask_b32 v238, v238, v239, s[54:55]
    v_cndmask_b32 v228, v228, v229, s[54:55]
    v_cndmask_b32 v230, v230, v231, s[54:55]
    v_cndmask_b32 v224, v232, v224, s[56:57]
    v_cndmask_b32 v225, v234, v226, s[58:59]
    v_cndmask_b32 v228, v236, v228, s[56:57]
    v_cndmask_b32 v229, v238, v230, s[58:59]
    s_waitcnt lgkmcnt(6)
    v_mul_f32 v224, v224, v190
    s_waitcnt lgkmcnt(5)
    v_mul_f32 v225, v225, v192
    s_waitcnt lgkmcnt(4)
    v_mul_f32 v228, v228, v194
    s_waitcnt lgkmcnt(3)
    v_mul_f32 v229, v229, v196
    v_max_f32 v222, v224, v225
    v_max_f32 v223, v228, v229
    s_nop 1
    v_permlane16_swap_b32 v222, v223
    v_max_f32 v222, v222, v223
    v_mov_b32 v223, v222
    s_nop 1
    v_permlane32_swap_b32 v222, v223
    v_max_f32 v222, v222, v223
    v_mov_b32 v223, v222
    s_nop 1
    v_permlane16_swap_b32 v222, v223
    v_sub_f32 v224, v224, v222
    v_sub_f32 v225, v225, v222
    v_sub_f32 v228, v228, v223
    v_sub_f32 v229, v229, v223
    v_fma_f32 v224, v224, v204, -v191
    v_fma_f32 v225, v225, v204, -v193
    v_fma_f32 v228, v228, v205, -v195
    v_fma_f32 v229, v229, v205, -v197
    v_exp_f32 v224, v224
    v_exp_f32 v225, v225
    v_exp_f32 v228, v228
    v_exp_f32 v229, v229
    v_cvt_pk_bf16_f32 v224, v224, v224
    v_cvt_pk_bf16_f32 v225, v225, v225
    v_cvt_pk_bf16_f32 v228, v228, v228
    v_cvt_pk_bf16_f32 v229, v229, v229
    v_and_b32 v232, v224, v32
    v_and_b32 v233, v225, v33
    v_and_b32 v234, v224, v34
    v_and_b32 v235, v225, v35
    v_and_b32 v236, v228, v32
    v_and_b32 v237, v229, v33
    v_and_b32 v238, v228, v34
    v_and_b32 v239, v229, v35
    s_waitcnt lgkmcnt(1)
    v_mfma_f32_16x16x32_bf16 v[160:163], v[198:201], v[232:235], 0
    s_waitcnt lgkmcnt(0)
    v_mfma_f32_16x16x32_bf16 v[164:167], v[200:203], v[236:239], 0
    v_mfma_f32_16x16x32_bf16 v[178:181], v[216:219], v[232:235], 0
    v_mfma_f32_16x16x32_bf16 v[182:185], v[218:221], v[236:239], 0
    s_nop 3
    v_rcp_f32 v160, v160
    s_nop 0
    v_rcp_f32 v164, v164
    v_mul_f32 v178, v178, v160
    v_mul_f32 v179, v179, v160
    v_mul_f32 v180, v180, v160
    v_mul_f32 v181, v181, v160
    v_mul_f32 v182, v182, v164
    v_mul_f32 v183, v183, v164
    v_mul_f32 v184, v184, v164
    v_mul_f32 v185, v185, v164
    v_cvt_pk_bf16_f32 v224, v178, v179
    v_cvt_pk_bf16_f32 v225, v180, v181
    v_cvt_pk_bf16_f32 v226, v182, v183
    v_cvt_pk_bf16_f32 v227, v184, v185
    s_nop 0
    v_permlane16_swap_b32 v224, v226
    v_permlane16_swap_b32 v225, v227
    buffer_store_dwordx4 v[224:227], v44, s[4:7], s41 offen sc1
w01_start:
    s_waitcnt vmcnt(1)
    ds_read_b32 v250, v62 offset:0
    v_lshlrev_b32 v76, 16, v240
    v_and_b32 v77, 0xffff0000, v240
    v_lshlrev_b32 v78, 16, v241
    v_and_b32 v79, 0xffff0000, v241
    v_lshlrev_b32 v80, 16, v242
    v_and_b32 v81, 0xffff0000, v242
    v_lshlrev_b32 v82, 16, v243
    v_and_b32 v83, 0xffff0000, v243
    s_waitcnt lgkmcnt(0)
    v_cmp_eq_u32 vcc, -1, v250
    s_cbranch_vccnz ps9
pe9:
    s_barrier
    ds_read_b128 v[132:135], v4 offset:0
    ds_read_b128 v[136:139], v4 offset:1024
    ds_read_b128 v[140:143], v4 offset:2048
    ds_read_b128 v[144:147], v4 offset:3072
    ds_read_b128 v[148:151], v4 offset:16384
    ds_read_b128 v[152:155], v4 offset:17408
    s_waitcnt lgkmcnt(5)
    v_mfma_f32_16x16x32_bf16 v[68:71], a[192:195], v[132:135], v[76:79]
    s_mov_b32 s41, 0
    ds_read_b128 v[156:159], v4 offset:18432
    v_and_b32 v124, 1, v3
    s_waitcnt lgkmcnt(5)
    v_mfma_f32_16x16x32_bf16 v[68:71], a[196:199], v[136:139], v[68:71]
    s_waitcnt lgkmcnt(3)
    ds_read_b128 v[160:163], v4 offset:19456
    v_lshl_add_u32 v124, v124, 4, v2
    v_mfma_f32_16x16x32_bf16 v[68:71], a[200:203], v[140:143], v[68:71]
    ds_read_b128 v[164:167], v4 offset:4096
    v_mul_u32_u24 v47, 144, v124
    v_mfma_f32_16x16x32_bf16 v[68:71], a[204:207], v[144:147], v[68:71]
    s_waitcnt lgkmcnt(3)
    ds_read_b128 v[168:171], v4 offset:5120
    v_lshrrev_b32 v124, 1, v3
    v_mfma_f32_16x16x32_bf16 v[72:75], a[192:195], v[148:151], v[80:83]
    s_lshl_b32 s44, s12, 5
    s_add_u32 s44, s44, 132032
    ds_read_b128 v[172:175], v4 offset:6144
    v_mfma_f32_16x16x32_bf16 v[72:75], a[196:199], v[152:155], v[72:75]
    s_waitcnt lgkmcnt(3)
    ds_read_b128 v[176:179], v4 offset:7168
    v_lshl_add_u32 v47, v124, 4, v47
    v_mfma_f32_16x16x32_bf16 v[72:75], a[200:203], v[156:159], v[72:75]
    ds_read_b128 v[180:183], v4 offset:20480
    v_add_u32 v47, s44, v47
    v_mfma_f32_16x16x32_bf16 v[72:75], a[204:207], v[160:163], v[72:75]
    s_waitcnt lgkmcnt(3)
    ds_read_b128 v[184:187], v4 offset:21504
    v_lshrrev_b32 v124, 3, v0
    v_mfma_f32_16x16x32_bf16 v[68:71], a[208:211], v[164:167], v[68:71]
    ds_read_b128 v[188:191], v4 offset:22528
    v_and_b32 v125, 7, v0
    v_mfma_f32_16x16x32_bf16 v[68:71], a[212:215], v[168:171], v[68:71]
    s_waitcnt lgkmcnt(3)
    ds_read_b128 v[192:195], v4 offset:23552
    v_lshlrev_b32 v125, 4, v125
    v_mfma_f32_16x16x32_bf16 v[68:71], a[216:219], v[172:175], v[68:71]
    ds_read_b128 v[132:135], v4 offset:8192
    v_mul_u32_u24 v48, 144, v124
    v_mfma_f32_16x16x32_bf16 v[68:71], a[220:223], v[176:179], v[68:71]
    s_waitcnt lgkmcnt(3)
    ds_read_b128 v[136:139], v4 offset:9216
    v_lshl_add_u32 v50, v124, 10, v125
    v_mfma_f32_16x16x32_bf16 v[72:75], a[208:211], v[180:183], v[72:75]
    s_lshl_b32 s43, s13, 15
    s_lshl_b32 s44, s14, 7
    ds_read_b128 v[140:143], v4 offset:10240
    v_mfma_f32_16x16x32_bf16 v[72:75], a[212:215], v[184:187], v[72:75]
    s_waitcnt lgkmcnt(3)
    s_add_u32 s43, s43, s44
    ds_read_b128 v[144:147], v4 offset:11264
    v_mfma_f32_16x16x32_bf16 v[72:75], a[216:219], v[188:191], v[72:75]
    ds_read_b128 v[148:151], v4 offset:24576
    v_add_u32 v48, v48, v125
    v_mfma_f32_16x16x32_bf16 v[72:75], a[220:223], v[192:195], v[72:75]
    s_waitcnt lgkmcnt(3)
    ds_read_b128 v[152:155], v4 offset:25600
    v_add_u32 v50, s43, v50
    v_mfma_f32_16x16x32_bf16 v[68:71], a[224:227], v[132:135], v[68:71]
    ds_read_b128 v[156:159], v4 offset:26624
    v_add_u32 v48, 132032, v48
    v_mfma_f32_16x16x32_bf16 v[68:71], a[228:231], v[136:139], v[68:71]
    s_waitcnt lgkmcnt(3)
    ds_read_b128 v[160:163], v4 offset:27648
    v_mfma_f32_16x16x32_bf16 v[68:71], a[232:235], v[140:143], v[68:71]
    ds_read_b128 v[164:167], v4 offset:12288
    v_mfma_f32_16x16x32_bf16 v[68:71], a[236:239], v[144:147], v[68:71]
    s_waitcnt lgkmcnt(3)
    ds_read_b128 v[168:171], v4 offset:13312
    v_mfma_f32_16x16x32_bf16 v[72:75], a[224:227], v[148:151], v[72:75]
    ds_read_b128 v[172:175], v4 offset:14336
    v_mfma_f32_16x16x32_bf16 v[72:75], a[228:231], v[152:155], v[72:75]
    s_waitcnt lgkmcnt(3)
    ds_read_b128 v[176:179], v4 offset:15360
    v_mfma_f32_16x16x32_bf16 v[72:75], a[232:235], v[156:159], v[72:75]
    ds_read_b128 v[180:183], v4 offset:28672
    v_mfma_f32_16x16x32_bf16 v[72:75], a[236:239], v[160:163], v[72:75]
    s_waitcnt lgkmcnt(3)
    ds_read_b128 v[184:187], v4 offset:29696
    v_mfma_f32_16x16x32_bf16 v[68:71], a[240:243], v[164:167], v[68:71]
    ds_read_b128 v[188:191], v4 offset:30720
    v_mfma_f32_16x16x32_bf16 v[68:71], a[244:247], v[168:171], v[68:71]
    s_waitcnt lgkmcnt(3)
    ds_read_b128 v[192:195], v4 offset:31744
    v_mfma_f32_16x16x32_bf16 v[68:71], a[248:251], v[172:175], v[68:71]
    v_mfma_f32_16x16x32_bf16 v[68:71], a[252:255], v[176:179], v[68:71]
    s_waitcnt lgkmcnt(2)
    v_mfma_f32_16x16x32_bf16 v[72:75], a[240:243], v[180:183], v[72:75]
    v_mfma_f32_16x16x32_bf16 v[72:75], a[244:247], v[184:187], v[72:75]
    s_waitcnt lgkmcnt(0)
    v_mfma_f32_16x16x32_bf16 v[72:75], a[248:251], v[188:191], v[72:75]
    v_mfma_f32_16x16x32_bf16 v[72:75], a[252:255], v[192:195], v[72:75]
    s_nop 7
    v_cmp_u_f32 vcc, v68, v72
    v_cvt_pk_bf16_f32 v116, v68, v69
    v_cvt_pk_bf16_f32 v117, v70, v71
    v_cvt_pk_bf16_f32 v118, v72, v73
    v_cvt_pk_bf16_f32 v119, v74, v75
    s_cbranch_vccnz rt10
rc10:
    v_permlane16_swap_b32 v116, v118
    v_permlane16_swap_b32 v117, v119
    ds_write_b128 v47, v[116:119] offset:0
    s_add_u32 s40, s74, 1048576
iw7:
    s_cbranch_execz iw_back
    s_add_u32 m0, s66, 32768
    s_nop 0
    buffer_load_dwordx4 v4, s[4:7], s40 offen offset:0 sc1 lds
    buffer_load_dwordx4 v4, s[4:7], s40 offen offset:1024 sc1 lds
    buffer_load_dwordx4 v4, s[4:7], s40 offen offset:2048 sc1 lds
    buffer_load_dwordx4 v4, s[4:7], s40 offen offset:3072 sc1 lds
    s_add_u32 s40, s74, 1064960
    s_add_u32 m0, s66, 49152
    s_nop 0
    buffer_load_dwordx4 v4, s[4:7], s40 offen offset:0 sc1 lds
    buffer_load_dwordx4 v4, s[4:7], s40 offen offset:1024 sc1 lds
    buffer_load_dwordx4 v4, s[4:7], s40 offen offset:2048 sc1 lds
    buffer_load_dwordx4 v4, s[4:7], s40 offen offset:3072 sc1 lds
    s_waitcnt lgkmcnt(0)
    s_barrier
    ds_read_b128 v[120:123], v48 offset:0
    s_waitcnt lgkmcnt(0)
    buffer_store_dwordx4 v[120:123], v50, s[8:11], s41 offen sc1
w11_start:
    s_waitcnt vmcnt(1)
    ds_read_b32 v250, v62 offset:32768
    v_lshlrev_b32 v76, 16, v244
    v_and_b32 v77, 0xffff0000, v244
    v_lshlrev_b32 v78, 16, v245
    v_and_b32 v79, 0xffff0000, v245
    v_lshlrev_b32 v80, 16, v246
    v_and_b32 v81, 0xffff0000, v246
    v_lshlrev_b32 v82, 16, v247
    v_and_b32 v83, 0xffff0000, v247
    s_waitcnt lgkmcnt(0)
    v_cmp_eq_u32 vcc, -1, v250
    s_cbranch_vccnz ps11
pe11:
    s_barrier
    ds_read_b128 v[132:135], v4 offset:32768
    ds_read_b128 v[136:139], v4 offset:33792
    ds_read_b128 v[140:143], v4 offset:34816
    ds_read_b128 v[144:147], v4 offset:35840
    ds_read_b128 v[148:151], v4 offset:49152
    ds_read_b128 v[152:155], v4 offset:50176
    s_waitcnt lgkmcnt(5)
    v_mfma_f32_16x16x32_bf16 v[68:71], a[192:195], v[132:135], v[76:79]
    s_mov_b32 s41, 1048576
    ds_read_b128 v[156:159], v4 offset:51200
    s_waitcnt lgkmcnt(5)
    v_mfma_f32_16x16x32_bf16 v[68:71], a[196:199], v[136:139], v[68:71]
    s_waitcnt lgkmcnt(3)
    ds_read_b128 v[160:163], v4 offset:52224
    v_mfma_f32_16x16x32_bf16 v[68:71], a[200:203], v[140:143], v[68:71]
    ds_read_b128 v[164:167], v4 offset:36864
    v_mfma_f32_16x16x32_bf16 v[68:71], a[204:207], v[144:147], v[68:71]
    s_waitcnt lgkmcnt(3)
    ds_read_b128 v[168:171], v4 offset:37888
    v_mfma_f32_16x16x32_bf16 v[72:75], a[192:195], v[148:151], v[80:83]
    ds_read_b128 v[172:175], v4 offset:38912
    v_mfma_f32_16x16x32_bf16 v[72:75], a[196:199], v[152:155], v[72:75]
    s_waitcnt lgkmcnt(3)
    ds_read_b128 v[176:179], v4 offset:39936
    v_mfma_f32_16x16x32_bf16 v[72:75], a[200:203], v[156:159], v[72:75]
    ds_read_b128 v[180:183], v4 offset:53248
    v_mfma_f32_16x16x32_bf16 v[72:75], a[204:207], v[160:163], v[72:75]
    s_waitcnt lgkmcnt(3)
    ds_read_b128 v[184:187], v4 offset:54272
    v_mfma_f32_16x16x32_bf16 v[68:71], a[208:211], v[164:167], v[68:71]
    ds_read_b128 v[188:191], v4 offset:55296
    v_mfma_f32_16x16x32_bf16 v[68:71], a[212:215], v[168:171], v[68:71]
    s_waitcnt lgkmcnt(3)
    ds_read_b128 v[192:195], v4 offset:56320
    v_mfma_f32_16x16x32_bf16 v[68:71], a[216:219], v[172:175], v[68:71]
    ds_read_b128 v[132:135], v4 offset:40960
    v_mfma_f32_16x16x32_bf16 v[68:71], a[220:223], v[176:179], v[68:71]
    s_waitcnt lgkmcnt(3)
    ds_read_b128 v[136:139], v4 offset:41984
    v_mfma_f32_16x16x32_bf16 v[72:75], a[208:211], v[180:183], v[72:75]
    ds_read_b128 v[140:143], v4 offset:43008
    v_mfma_f32_16x16x32_bf16 v[72:75], a[212:215], v[184:187], v[72:75]
    s_waitcnt lgkmcnt(3)
    ds_read_b128 v[144:147], v4 offset:44032
    v_mfma_f32_16x16x32_bf16 v[72:75], a[216:219], v[188:191], v[72:75]
    ds_read_b128 v[148:151], v4 offset:57344
    v_mfma_f32_16x16x32_bf16 v[72:75], a[220:223], v[192:195], v[72:75]
    s_waitcnt lgkmcnt(3)
    ds_read_b128 v[152:155], v4 offset:58368
    v_mfma_f32_16x16x32_bf16 v[68:71], a[224:227], v[132:135], v[68:71]
    ds_read_b128 v[156:159], v4 offset:59392
    v_mfma_f32_16x16x32_bf16 v[68:71], a[228:231], v[136:139], v[68:71]
    s_waitcnt lgkmcnt(3)
    ds_read_b128 v[160:163], v4 offset:60416
    v_mfma_f32_16x16x32_bf16 v[68:71], a[232:235], v[140:143], v[68:71]
    ds_read_b128 v[164:167], v4 offset:45056
    v_mfma_f32_16x16x32_bf16 v[68:71], a[236:239], v[144:147], v[68:71]
    s_waitcnt lgkmcnt(3)
    ds_read_b128 v[168:171], v4 offset:46080
    v_mfma_f32_16x16x32_bf16 v[72:75], a[224:227], v[148:151], v[72:75]
    ds_read_b128 v[172:175], v4 offset:47104
    v_mfma_f32_16x16x32_bf16 v[72:75], a[228:231], v[152:155], v[72:75]
    s_waitcnt lgkmcnt(3)
    ds_read_b128 v[176:179], v4 offset:48128
    v_mfma_f32_16x16x32_bf16 v[72:75], a[232:235], v[156:159], v[72:75]
    ds_read_b128 v[180:183], v4 offset:61440
    v_mfma_f32_16x16x32_bf16 v[72:75], a[236:239], v[160:163], v[72:75]
    s_waitcnt lgkmcnt(3)
    ds_read_b128 v[184:187], v4 offset:62464
    v_mfma_f32_16x16x32_bf16 v[68:71], a[240:243], v[164:167], v[68:71]
    ds_read_b128 v[188:191], v4 offset:63488
    v_mfma_f32_16x16x32_bf16 v[68:71], a[244:247], v[168:171], v[68:71]
    s_waitcnt lgkmcnt(3)
    ds_read_b128 v[192:195], v4 offset:64512
    v_mfma_f32_16x16x32_bf16 v[68:71], a[248:251], v[172:175], v[68:71]
    v_mfma_f32_16x16x32_bf16 v[68:71], a[252:255], v[176:179], v[68:71]
    s_waitcnt lgkmcnt(2)
    v_mfma_f32_16x16x32_bf16 v[72:75], a[240:243], v[180:183], v[72:75]
    v_mfma_f32_16x16x32_bf16 v[72:75], a[244:247], v[184:187], v[72:75]
    s_waitcnt lgkmcnt(0)
    v_mfma_f32_16x16x32_bf16 v[72:75], a[248:251], v[188:191], v[72:75]
    v_mfma_f32_16x16x32_bf16 v[72:75], a[252:255], v[192:195], v[72:75]
    s_nop 7
    v_cmp_u_f32 vcc, v68, v72
    v_cvt_pk_bf16_f32 v116, v68, v69
    v_cvt_pk_bf16_f32 v117, v70, v71
    v_cvt_pk_bf16_f32 v118, v72, v73
    v_cvt_pk_bf16_f32 v119, v74, v75
    s_cbranch_vccnz rt12
rc12:
    v_permlane16_swap_b32 v116, v118
    v_permlane16_swap_b32 v117, v119
    ds_write_b128 v47, v[116:119] offset:4608
    s_waitcnt lgkmcnt(0)
    s_barrier
    ds_read_b128 v[120:123], v48 offset:4608
    s_waitcnt lgkmcnt(0)
    buffer_store_dwordx4 v[120:123], v50, s[8:11], s41 offen sc1
the_end:
    s_endpgm
rt4:
    s_cmp_eq_u32 s26, 0
    s_cbranch_scc1 rc4
    s_sub_u32 s26, s26, 1
    s_waitcnt vmcnt(0) lgkmcnt(0)
    s_barrier
    s_add_u32 s40, s74, 0
    s_add_u32 m0, s66, 0
    s_nop 0
    buffer_load_dwordx4 v4, s[4:7], s40 offen offset:0 sc1 lds
    buffer_load_dwordx4 v4, s[4:7], s40 offen offset:1024 sc1 lds
    buffer_load_dwordx4 v4, s[4:7], s40 offen offset:2048 sc1 lds
    buffer_load_dwordx4 v4, s[4:7], s40 offen offset:3072 sc1 lds
    s_add_u32 s40, s74, 16384
    s_add_u32 m0, s66, 16384
    s_nop 0
    buffer_load_dwordx4 v4, s[4:7], s40 offen offset:0 sc1 lds
    buffer_load_dwordx4 v4, s[4:7], s40 offen offset:1024 sc1 lds
    buffer_load_dwordx4 v4, s[4:7], s40 offen offset:2048 sc1 lds
    buffer_load_dwordx4 v4, s[4:7], s40 offen offset:3072 sc1 lds
    s_waitcnt vmcnt(0)
    s_nop 7
    s_branch w00_start
rt6:
    s_cmp_eq_u32 s26, 0
    s_cbranch_scc1 rc6
    s_sub_u32 s26, s26, 1
    s_waitcnt vmcnt(0) lgkmcnt(0)
    s_barrier
    s_add_u32 s40, s74, 1048576
    s_add_u32 m0, s66, 32768
    s_nop 0
    buffer_load_dwordx4 v4, s[4:7], s40 offen offset:0 sc1 lds
    buffer_load_dwordx4 v4, s[4:7], s40 offen offset:1024 sc1 lds
    buffer_load_dwordx4 v4, s[4:7], s40 offen offset:2048 sc1 lds
    buffer_load_dwordx4 v4, s[4:7], s40 offen offset:3072 sc1 lds
    s_add_u32 s40, s74, 1064960
    s_add_u32 m0, s66, 49152
    s_nop 0
    buffer_load_dwordx4 v4, s[4:7], s40 offen offset:0 sc1 lds
    buffer_load_dwordx4 v4, s[4:7], s40 offen offset:1024 sc1 lds
    buffer_load_dwordx4 v4, s[4:7], s40 offen offset:2048 sc1 lds
    buffer_load_dwordx4 v4, s[4:7], s40 offen offset:3072 sc1 lds
    s_waitcnt vmcnt(0)
    s_nop 7
    s_branch w10_start
rt10:
    s_cmp_eq_u32 s26, 0
    s_cbranch_scc1 rc10
    s_sub_u32 s26, s26, 1
    s_waitcnt vmcnt(0) lgkmcnt(0)
    s_barrier
    s_add_u32 s40, s74, 0
    s_add_u32 m0, s66, 0
    s_nop 0
    buffer_load_dwordx4 v4, s[4:7], s40 offen offset:0 sc1 lds
    buffer_load_dwordx4 v4, s[4:7], s40 offen offset:1024 sc1 lds
    buffer_load_dwordx4 v4, s[4:7], s40 offen offset:2048 sc1 lds
    buffer_load_dwordx4 v4, s[4:7], s40 offen offset:3072 sc1 lds
    s_add_u32 s40, s74, 16384
    s_add_u32 m0, s66, 16384
    s_nop 0
    buffer_load_dwordx4 v4, s[4:7], s40 offen offset:0 sc1 lds
    buffer_load_dwordx4 v4, s[4:7], s40 offen offset:1024 sc1 lds
    buffer_load_dwordx4 v4, s[4:7], s40 offen offset:2048 sc1 lds
    buffer_load_dwordx4 v4, s[4:7], s40 offen offset:3072 sc1 lds
    s_waitcnt vmcnt(0)
    s_nop 7
    s_branch w01_start
rt12:
    s_cmp_eq_u32 s26, 0
    s_cbranch_scc1 rc12
    s_sub_u32 s26, s26, 1
    s_waitcnt vmcnt(0) lgkmcnt(0)
    s_barrier
    s_add_u32 s40, s74, 1048576
    s_add_u32 m0, s66, 32768
    s_nop 0
    buffer_load_dwordx4 v4, s[4:7], s40 offen offset:0 sc1 lds
    buffer_load_dwordx4 v4, s[4:7], s40 offen offset:1024 sc1 lds
    buffer_load_dwordx4 v4, s[4:7], s40 offen offset:2048 sc1 lds
    buffer_load_dwordx4 v4, s[4:7], s40 offen offset:3072 sc1 lds
    s_add_u32 s40, s74, 1064960
    s_add_u32 m0, s66, 49152
    s_nop 0
    buffer_load_dwordx4 v4, s[4:7], s40 offen offset:0 sc1 lds
    buffer_load_dwordx4 v4, s[4:7], s40 offen offset:1024 sc1 lds
    buffer_load_dwordx4 v4, s[4:7], s40 offen offset:2048 sc1 lds
    buffer_load_dwordx4 v4, s[4:7], s40 offen offset:3072 sc1 lds
    s_waitcnt vmcnt(0)
    s_nop 7
    s_branch w11_start
ps2:
    s_mov_b32 s63, 524288
pl2:
    buffer_load_dword v250, v61, s[4:7], s46 offen sc1
    s_waitcnt vmcnt(0)
    v_cmp_ne_u32 vcc, s45, v250
    s_cbranch_vccz pe2
pn2:
    s_sub_u32 s63, s63, 1
    s_cbranch_scc0 pl2
    s_branch pe2
ps3:
    s_mov_b32 s63, 524288
pl3:
    s_add_u32 s40, s74, 0
    s_add_u32 m0, s66, 0
    s_nop 0
    buffer_load_dwordx4 v4, s[4:7], s40 offen offset:0 sc1 lds
    buffer_load_dwordx4 v4, s[4:7], s40 offen offset:1024 sc1 lds
    buffer_load_dwordx4 v4, s[4:7], s40 offen offset:2048 sc1 lds
    buffer_load_dwordx4 v4, s[4:7], s40 offen offset:3072 sc1 lds
    s_add_u32 s40, s74, 16384
    s_add_u32 m0, s66, 16384
    s_nop 0
    buffer_load_dwordx4 v4, s[4:7], s40 offen offset:0 sc1 lds
    buffer_load_dwordx4 v4, s[4:7], s40 offen offset:1024 sc1 lds
    buffer_load_dwordx4 v4, s[4:7], s40 offen offset:2048 sc1 lds
    buffer_load_dwordx4 v4, s[4:7], s40 offen offset:3072 sc1 lds
    s_waitcnt vmcnt(0)
    ds_read_b32 v250, v62 offset:0
    s_waitcnt lgkmcnt(0)
    v_cmp_eq_u32 vcc, -1, v250
    s_cbranch_vccz pe3
pn3:
    s_sub_u32 s63, s63, 1
    s_cbranch_scc0 pl3
    s_branch pe3
ps5:
    s_mov_b32 s63, 524288
pl5:
    s_add_u32 s40, s74, 1048576
    s_add_u32 m0, s66, 32768
    s_nop 0
    buffer_load_dwordx4 v4, s[4:7], s40 offen offset:0 sc1 lds
    buffer_load_dwordx4 v4, s[4:7], s40 offen offset:1024 sc1 lds
    buffer_load_dwordx4 v4, s[4:7], s40 offen offset:2048 sc1 lds
    buffer_load_dwordx4 v4, s[4:7], s40 offen offset:3072 sc1 lds
    s_add_u32 s40, s74, 1064960
    s_add_u32 m0, s66, 49152
    s_nop 0
    buffer_load_dwordx4 v4, s[4:7], s40 offen offset:0 sc1 lds
    buffer_load_dwordx4 v4, s[4:7], s40 offen offset:1024 sc1 lds
    buffer_load_dwordx4 v4, s[4:7], s40 offen offset:2048 sc1 lds
    buffer_load_dwordx4 v4, s[4:7], s40 offen offset:3072 sc1 lds
    s_waitcnt vmcnt(0)
    ds_read_b32 v250, v62 offset:32768
    s_waitcnt lgkmcnt(0)
    v_cmp_eq_u32 vcc, -1, v250
    s_cbranch_vccz pe5
pn5:
    s_sub_u32 s63, s63, 1
    s_cbranch_scc0 pl5
    s_branch pe5
ps7:
iw8:
    s_cbranch_execz iw_back
    s_mov_b32 s63, 524288
    s_mov_b32 s18, 14712832
    s_add_u32 s23, s75, 4194304
    buffer_load_dwordx4 v[212:215], v5, s[4:7], s23 offen sc1
    s_branch pm7
pl7:
    s_mov_b32 s18, 14712832
    s_add_u32 s23, s75, 4194304
    s_waitcnt vmcnt(0)
    buffer_load_dwordx4 v[212:215], v5, s[4:7], s23 offen sc1
    s_waitcnt vmcnt(0)
    v_max3_u32 v222, v212, v213, v214
    v_max_u32 v222, v222, v215
    v_cmp_eq_u32 vcc, -1, v222
    s_cbranch_vccnz pn7
pm7:
    buffer_load_dwordx4 v[216:219], v6, s[4:7], s18 offen offset:0 sc1
    buffer_load_dwordx4 v[220:223], v6, s[4:7], s18 offen offset:1024 sc1
    buffer_load_dwordx4 v[224:227], v6, s[4:7], s18 offen offset:2048 sc1
    buffer_load_dwordx4 v[228:231], v6, s[4:7], s18 offen offset:3072 sc1
    s_waitcnt vmcnt(0)
    v_min3_f32 v218, v218, v222, v226
    v_max3_u32 v222, v212, v213, v214
    v_min_f32 v218, v218, v230
    v_max_u32 v222, v222, v215
    v_cmp_gt_f32 vcc, 0x41000000, v218
    v_cmp_eq_u32 s[20:21], -1, v222
    s_nop 3
    s_or_b64 vcc, vcc, s[20:21]
    s_cbranch_vccz pe7
pn7:
    s_sub_u32 s63, s63, 1
    s_cbranch_scc0 pl7
    s_branch pe7
ps8:
    s_mov_b32 s63, 524288
    s_mov_b32 s18, 14729216
    s_add_u32 s23, s75, 5242880
    buffer_load_dwordx4 v[212:215], v5, s[4:7], s23 offen sc1
    s_branch pm8
pl8:
    s_mov_b32 s18, 14729216
    s_add_u32 s23, s75, 5242880
    s_waitcnt vmcnt(0)
    buffer_load_dwordx4 v[212:215], v5, s[4:7], s23 offen sc1
    s_waitcnt vmcnt(0)
    v_max3_u32 v222, v212, v213, v214
    v_max_u32 v222, v222, v215
    v_cmp_eq_u32 vcc, -1, v222
    s_cbranch_vccnz pn8
pm8:
    buffer_load_dwordx4 v[216:219], v6, s[4:7], s18 offen offset:0 sc1
    buffer_load_dwordx4 v[220:223], v6, s[4:7], s18 offen offset:1024 sc1
    buffer_load_dwordx4 v[224:227], v6, s[4:7], s18 offen offset:2048 sc1
    buffer_load_dwordx4 v[228:231], v6, s[4:7], s18 offen offset:3072 sc1
    s_waitcnt vmcnt(0)
    v_min3_f32 v218, v218, v222, v226
    v_max3_u32 v222, v212, v213, v214
    v_min_f32 v218, v218, v230
    v_max_u32 v222, v222, v215
    v_cmp_gt_f32 vcc, 0x41000000, v218
    v_cmp_eq_u32 s[20:21], -1, v222
    s_nop 3
    s_or_b64 vcc, vcc, s[20:21]
    s_cbranch_vccz pe8
pn8:
    s_sub_u32 s63, s63, 1
    s_cbranch_scc0 pl8
    s_branch pe8
ps9:
    s_mov_b32 s63, 524288
pl9:
    s_add_u32 s40, s74, 0
    s_add_u32 m0, s66, 0
    s_nop 0
    buffer_load_dwordx4 v4, s[4:7], s40 offen offset:0 sc1 lds
    buffer_load_dwordx4 v4, s[4:7], s40 offen offset:1024 sc1 lds
    buffer_load_dwordx4 v4, s[4:7], s40 offen offset:2048 sc1 lds
    buffer_load_dwordx4 v4, s[4:7], s40 offen offset:3072 sc1 lds
    s_add_u32 s40, s74, 16384
    s_add_u32 m0, s66, 16384
    s_nop 0
    buffer_load_dwordx4 v4, s[4:7], s40 offen offset:0 sc1 lds
    buffer_load_dwordx4 v4, s[4:7], s40 offen offset:1024 sc1 lds
    buffer_load_dwordx4 v4, s[4:7], s40 offen offset:2048 sc1 lds
    buffer_load_dwordx4 v4, s[4:7], s40 offen offset:3072 sc1 lds
    s_waitcnt vmcnt(0)
    ds_read_b32 v250, v62 offset:0
    s_waitcnt lgkmcnt(0)
    v_cmp_eq_u32 vcc, -1, v250
    s_cbranch_vccz pe9
pn9:
    s_sub_u32 s63, s63, 1
    s_cbranch_scc0 pl9
    s_branch pe9
ps11:
    s_mov_b32 s63, 524288
pl11:
    s_add_u32 s40, s74, 1048576
    s_add_u32 m0, s66, 32768
    s_nop 0
    buffer_load_dwordx4 v4, s[4:7], s40 offen offset:0 sc1 lds
    buffer_load_dwordx4 v4, s[4:7], s40 offen offset:1024 sc1 lds
    buffer_load_dwordx4 v4, s[4:7], s40 offen offset:2048 sc1 lds
    buffer_load_dwordx4 v4, s[4:7], s40 offen offset:3072 sc1 lds
    s_add_u32 s40, s74, 1064960
    s_add_u32 m0, s66, 49152
    s_nop 0
    buffer_load_dwordx4 v4, s[4:7], s40 offen offset:0 sc1 lds
    buffer_load_dwordx4 v4, s[4:7], s40 offen offset:1024 sc1 lds
    buffer_load_dwordx4 v4, s[4:7], s40 offen offset:2048 sc1 lds
    buffer_load_dwordx4 v4, s[4:7], s40 offen offset:3072 sc1 lds
    s_waitcnt vmcnt(0)
    ds_read_b32 v250, v62 offset:32768
    s_waitcnt lgkmcnt(0)
    v_cmp_eq_u32 vcc, -1, v250
    s_cbranch_vccz pe11
pn11:
    s_sub_u32 s63, s63, 1
    s_cbranch_scc0 pl11
    s_branch pe11
sr00:
    s_cmp_eq_u32 s27, 0
    s_cbranch_scc1 so00
    s_sub_u32 s27, s27, 1
    s_add_u32 s36, s64, 0
    s_add_u32 s38, s36, 16384
    s_sub_u32 s37, s36, s65
    s_add_u32 m0, s66, 65536
    s_nop 0
    buffer_load_dwordx4 v4, s[4:7], s37 offen offset:0 sc1 lds
    s_add_u32 m0, s66, 0
    s_nop 0
    buffer_load_dwordx4 v4, s[4:7], s36 offen offset:0 sc1 lds
    s_add_u32 m0, s66, 16384
    s_nop 0
    buffer_load_dwordx4 v4, s[4:7], s38 offen offset:0 sc1 lds
    s_add_u32 m0, s66, 65536
    s_nop 0
    buffer_load_dwordx4 v4, s[4:7], s37 offen offset:1024 sc1 lds
    s_add_u32 m0, s66, 0
    s_nop 0
    buffer_load_dwordx4 v4, s[4:7], s36 offen offset:1024 sc1 lds
    s_add_u32 m0, s66, 16384
    s_nop 0
    buffer_load_dwordx4 v4, s[4:7], s38 offen offset:1024 sc1 lds
    s_add_u32 m0, s66, 65536
    s_nop 0
    buffer_load_dwordx4 v4, s[4:7], s37 offen offset:2048 sc1 lds
    s_add_u32 m0, s66, 0
    s_nop 0
    buffer_load_dwordx4 v4, s[4:7], s36 offen offset:2048 sc1 lds
    s_add_u32 m0, s66, 16384
    s_nop 0
    buffer_load_dwordx4 v4, s[4:7], s38 offen offset:2048 sc1 lds
    s_add_u32 m0, s66, 65536
    s_nop 0
    buffer_load_dwordx4 v4, s[4:7], s37 offen offset:3072 sc1 lds
    s_add_u32 m0, s66, 0
    s_nop 0
    buffer_load_dwordx4 v4, s[4:7], s36 offen offset:3072 sc1 lds
    s_add_u32 m0, s66, 16384
    s_nop 0
    buffer_load_dwordx4 v4, s[4:7], s38 offen offset:3072 sc1 lds
    s_waitcnt vmcnt(0) lgkmcnt(0)
    ds_read_b64_tr_b16 v[124:125], v43 offset:0
    ds_read_b64_tr_b16 v[126:127], v43 offset:512
    ds_read_b64_tr_b16 v[128:129], v42 offset:0
    ds_read_b64_tr_b16 v[130:131], v42 offset:512
    ds_read_b64_tr_b16 v[132:133], v42 offset:16384
    ds_read_b64_tr_b16 v[134:135], v42 offset:16896
    ds_read_b64_tr_b16 v[136:137], v43 offset:1024
    ds_read_b64_tr_b16 v[138:139], v43 offset:1536
    ds_read_b64_tr_b16 v[140:141], v42 offset:1024
    ds_read_b64_tr_b16 v[142:143], v42 offset:1536
    ds_read_b64_tr_b16 v[144:145], v42 offset:17408
    ds_read_b64_tr_b16 v[146:147], v42 offset:17920
    ds_read_b64_tr_b16 v[148:149], v43 offset:2048
    ds_read_b64_tr_b16 v[150:151], v43 offset:2560
    ds_read_b64_tr_b16 v[152:153], v42 offset:2048
    ds_read_b64_tr_b16 v[154:155], v42 offset:2560
    ds_read_b64_tr_b16 v[156:157], v42 offset:18432
    ds_read_b64_tr_b16 v[158:159], v42 offset:18944
    ds_read_b64_tr_b16 v[178:179], v43 offset:3072
    ds_read_b64_tr_b16 v[180:181], v43 offset:3584
    ds_read_b64_tr_b16 v[182:183], v42 offset:3072
    ds_read_b64_tr_b16 v[184:185], v42 offset:3584
    ds_read_b64_tr_b16 v[186:187], v42 offset:19456
    ds_read_b64_tr_b16 v[188:189], v42 offset:19968
    s_waitcnt lgkmcnt(15)
    v_mfma_f32_16x16x32_bf16 v[112:115], v[16:19], v[124:127], 0
    v_mfma_f32_16x16x32_bf16 v[116:119], v[16:19], v[128:131], 0
    v_mfma_f32_16x16x32_bf16 v[120:123], v[16:19], v[132:135], 0
    v_mfma_f32_16x16x32_bf16 v[100:103], v[124:127], v[124:127], 0
    v_mfma_f32_16x16x32_bf16 v[104:107], v[128:131], v[128:131], 0
    v_mfma_f32_16x16x32_bf16 v[108:111], v[132:135], v[132:135], 0
    v_mfma_f32_16x16x32_bf16 v[112:115], v[16:19], v[136:139], v[112:115]
    s_waitcnt lgkmcnt(14)
    v_mfma_f32_16x16x32_bf16 v[116:119], v[16:19], v[140:143], v[116:119]
    s_waitcnt lgkmcnt(12)
    v_mfma_f32_16x16x32_bf16 v[120:123], v[16:19], v[144:147], v[120:123]
    s_waitcnt lgkmcnt(10)
    v_mfma_f32_16x16x32_bf16 v[112:115], v[16:19], v[148:151], v[112:115]
    s_waitcnt lgkmcnt(8)
    v_mfma_f32_16x16x32_bf16 v[116:119], v[16:19], v[152:155], v[116:119]
    s_waitcnt lgkmcnt(6)
    v_mfma_f32_16x16x32_bf16 v[120:123], v[16:19], v[156:159], v[120:123]
    s_waitcnt lgkmcnt(4)
    v_mfma_f32_16x16x32_bf16 v[112:115], v[16:19], v[178:181], v[112:115]
    s_waitcnt lgkmcnt(2)
    v_mfma_f32_16x16x32_bf16 v[116:119], v[16:19], v[182:185], v[116:119]
    s_waitcnt lgkmcnt(0)
    v_mfma_f32_16x16x32_bf16 v[120:123], v[16:19], v[186:189], v[120:123]
    v_mfma_f32_16x16x32_bf16 v[100:103], v[136:139], v[136:139], v[100:103]
    v_mfma_f32_16x16x32_bf16 v[104:107], v[140:143], v[140:143], v[104:107]
    v_mfma_f32_16x16x32_bf16 v[108:111], v[144:147], v[144:147], v[108:111]
    v_mfma_f32_16x16x32_bf16 v[100:103], v[148:151], v[148:151], v[100:103]
    s_nop 1
    v_add_f32 v252, v112, v116
    s_nop 0
    v_cmp_u_f32 vcc, v252, v120
    s_cbranch_vccnz sr00
    s_branch so00
sr01:
    s_cmp_eq_u32 s27, 0
    s_cbranch_scc1 so01
    s_sub_u32 s27, s27, 1
    s_add_u32 s36, s64, 1048576
    s_add_u32 s38, s36, 16384
    s_sub_u32 s37, s36, 16384
    s_add_u32 m0, s66, 81920
    s_nop 0
    buffer_load_dwordx4 v4, s[4:7], s37 offen offset:0 sc1 lds
    s_add_u32 m0, s66, 32768
    s_nop 0
    buffer_load_dwordx4 v4, s[4:7], s36 offen offset:0 sc1 lds
    s_add_u32 m0, s66, 49152
    s_nop 0
    buffer_load_dwordx4 v4, s[4:7], s38 offen offset:0 sc1 lds
    s_add_u32 m0, s66, 81920
    s_nop 0
    buffer_load_dwordx4 v4, s[4:7], s37 offen offset:1024 sc1 lds
    s_add_u32 m0, s66, 32768
    s_nop 0
    buffer_load_dwordx4 v4, s[4:7], s36 offen offset:1024 sc1 lds
    s_add_u32 m0, s66, 49152
    s_nop 0
    buffer_load_dwordx4 v4, s[4:7], s38 offen offset:1024 sc1 lds
    s_add_u32 m0, s66, 81920
    s_nop 0
    buffer_load_dwordx4 v4, s[4:7], s37 offen offset:2048 sc1 lds
    s_add_u32 m0, s66, 32768
    s_nop 0
    buffer_load_dwordx4 v4, s[4:7], s36 offen offset:2048 sc1 lds
    s_add_u32 m0, s66, 49152
    s_nop 0
    buffer_load_dwordx4 v4, s[4:7], s38 offen offset:2048 sc1 lds
    s_add_u32 m0, s66, 81920
    s_nop 0
    buffer_load_dwordx4 v4, s[4:7], s37 offen offset:3072 sc1 lds
    s_add_u32 m0, s66, 32768
    s_nop 0
    buffer_load_dwordx4 v4, s[4:7], s36 offen offset:3072 sc1 lds
    s_add_u32 m0, s66, 49152
    s_nop 0
    buffer_load_dwordx4 v4, s[4:7], s38 offen offset:3072 sc1 lds
    s_waitcnt vmcnt(0) lgkmcnt(0)
    ds_read_b64_tr_b16 v[124:125], v43 offset:16384
    ds_read_b64_tr_b16 v[126:127], v43 offset:16896
    ds_read_b64_tr_b16 v[128:129], v42 offset:32768
    ds_read_b64_tr_b16 v[130:131], v42 offset:33280
    ds_read_b64_tr_b16 v[132:133], v42 offset:49152
    ds_read_b64_tr_b16 v[134:135], v42 offset:49664
    ds_read_b64_tr_b16 v[136:137], v43 offset:17408
    ds_read_b64_tr_b16 v[138:139], v43 offset:17920
    ds_read_b64_tr_b16 v[140:141], v42 offset:33792
    ds_read_b64_tr_b16 v[142:143], v42 offset:34304
    ds_read_b64_tr_b16 v[144:145], v42 offset:50176
    ds_read_b64_tr_b16 v[146:147], v42 offset:50688
    ds_read_b64_tr_b16 v[148:149], v43 offset:18432
    ds_read_b64_tr_b16 v[150:151], v43 offset:18944
    ds_read_b64_tr_b16 v[152:153], v42 offset:34816
    ds_read_b64_tr_b16 v[154:155], v42 offset:35328
    ds_read_b64_tr_b16 v[156:157], v42 offset:51200
    ds_read_b64_tr_b16 v[158:159], v42 offset:51712
    ds_read_b64_tr_b16 v[178:179], v43 offset:19456
    ds_read_b64_tr_b16 v[180:181], v43 offset:19968
    ds_read_b64_tr_b16 v[182:183], v42 offset:35840
    ds_read_b64_tr_b16 v[184:185], v42 offset:36352
    ds_read_b64_tr_b16 v[186:187], v42 offset:52224
    ds_read_b64_tr_b16 v[188:189], v42 offset:52736
    s_waitcnt lgkmcnt(15)
    v_mfma_f32_16x16x32_bf16 v[112:115], v[16:19], v[124:127], 0
    v_mfma_f32_16x16x32_bf16 v[116:119], v[16:19], v[128:131], 0
    v_mfma_f32_16x16x32_bf16 v[120:123], v[16:19], v[132:135], 0
    v_mfma_f32_16x16x32_bf16 v[100:103], v[124:127], v[124:127], 0
    v_mfma_f32_16x16x32_bf16 v[104:107], v[128:131], v[128:131], 0
    v_mfma_f32_16x16x32_bf16 v[108:111], v[132:135], v[132:135], 0
    v_mfma_f32_16x16x32_bf16 v[112:115], v[16:19], v[136:139], v[112:115]
    s_waitcnt lgkmcnt(14)
    v_mfma_f32_16x16x32_bf16 v[116:119], v[16:19], v[140:143], v[116:119]
    s_waitcnt lgkmcnt(12)
    v_mfma_f32_16x16x32_bf16 v[120:123], v[16:19], v[144:147], v[120:123]
    s_waitcnt lgkmcnt(10)
    v_mfma_f32_16x16x32_bf16 v[112:115], v[16:19], v[148:151], v[112:115]
    s_waitcnt lgkmcnt(8)
    v_mfma_f32_16x16x32_bf16 v[116:119], v[16:19], v[152:155], v[116:119]
    s_waitcnt lgkmcnt(6)
    v_mfma_f32_16x16x32_bf16 v[120:123], v[16:19], v[156:159], v[120:123]
    s_waitcnt lgkmcnt(4)
    v_mfma_f32_16x16x32_bf16 v[112:115], v[16:19], v[178:181], v[112:115]
    s_waitcnt lgkmcnt(2)
    v_mfma_f32_16x16x32_bf16 v[116:119], v[16:19], v[182:185], v[116:119]
    s_waitcnt lgkmcnt(0)
    v_mfma_f32_16x16x32_bf16 v[120:123], v[16:19], v[186:189], v[120:123]
    v_mfma_f32_16x16x32_bf16 v[100:103], v[136:139], v[136:139], v[100:103]
    v_mfma_f32_16x16x32_bf16 v[104:107], v[140:143], v[140:143], v[104:107]
    v_mfma_f32_16x16x32_bf16 v[108:111], v[144:147], v[144:147], v[108:111]
    v_mfma_f32_16x16x32_bf16 v[100:103], v[148:151], v[148:151], v[100:103]
    s_nop 1
    v_add_f32 v252, v112, v116
    s_nop 0
    v_cmp_u_f32 vcc, v252, v120
    s_cbranch_vccnz sr01
    s_branch so01
sr10:
    s_cmp_eq_u32 s27, 0
    s_cbranch_scc1 so10
    s_sub_u32 s27, s27, 1
    s_add_u32 s36, s64, 0
    s_add_u32 s38, s36, 16384
    s_sub_u32 s37, s36, s65
    s_add_u32 m0, s66, 65536
    s_nop 0
    buffer_load_dwordx4 v4, s[4:7], s37 offen offset:0 sc1 lds
    s_add_u32 m0, s66, 0
    s_nop 0
    buffer_load_dwordx4 v4, s[4:7], s36 offen offset:0 sc1 lds
    s_add_u32 m0, s66, 16384
    s_nop 0
    buffer_load_dwordx4 v4, s[4:7], s38 offen offset:0 sc1 lds
    s_add_u32 m0, s66, 65536
    s_nop 0
    buffer_load_dwordx4 v4, s[4:7], s37 offen offset:1024 sc1 lds
    s_add_u32 m0, s66, 0
    s_nop 0
    buffer_load_dwordx4 v4, s[4:7], s36 offen offset:1024 sc1 lds
    s_add_u32 m0, s66, 16384
    s_nop 0
    buffer_load_dwordx4 v4, s[4:7], s38 offen offset:1024 sc1 lds
    s_add_u32 m0, s66, 65536
    s_nop 0
    buffer_load_dwordx4 v4, s[4:7], s37 offen offset:2048 sc1 lds
    s_add_u32 m0, s66, 0
    s_nop 0
    buffer_load_dwordx4 v4, s[4:7], s36 offen offset:2048 sc1 lds
    s_add_u32 m0, s66, 16384
    s_nop 0
    buffer_load_dwordx4 v4, s[4:7], s38 offen offset:2048 sc1 lds
    s_add_u32 m0, s66, 65536
    s_nop 0
    buffer_load_dwordx4 v4, s[4:7], s37 offen offset:3072 sc1 lds
    s_add_u32 m0, s66, 0
    s_nop 0
    buffer_load_dwordx4 v4, s[4:7], s36 offen offset:3072 sc1 lds
    s_add_u32 m0, s66, 16384
    s_nop 0
    buffer_load_dwordx4 v4, s[4:7], s38 offen offset:3072 sc1 lds
    s_waitcnt vmcnt(0) lgkmcnt(0)
    ds_read_b64_tr_b16 v[124:125], v43 offset:0
    ds_read_b64_tr_b16 v[126:127], v43 offset:512
    ds_read_b64_tr_b16 v[128:129], v42 offset:0
    ds_read_b64_tr_b16 v[130:131], v42 offset:512
    ds_read_b64_tr_b16 v[132:133], v42 offset:16384
    ds_read_b64_tr_b16 v[134:135], v42 offset:16896
    ds_read_b64_tr_b16 v[136:137], v43 offset:1024
    ds_read_b64_tr_b16 v[138:139], v43 offset:1536
    ds_read_b64_tr_b16 v[140:141], v42 offset:1024
    ds_read_b64_tr_b16 v[142:143], v42 offset:1536
    ds_read_b64_tr_b16 v[144:145], v42 offset:17408
    ds_read_b64_tr_b16 v[146:147], v42 offset:17920
    ds_read_b64_tr_b16 v[148:149], v43 offset:2048
    ds_read_b64_tr_b16 v[150:151], v43 offset:2560
    ds_read_b64_tr_b16 v[152:153], v42 offset:2048
    ds_read_b64_tr_b16 v[154:155], v42 offset:2560
    ds_read_b64_tr_b16 v[156:157], v42 offset:18432
    ds_read_b64_tr_b16 v[158:159], v42 offset:18944
    ds_read_b64_tr_b16 v[178:179], v43 offset:3072
    ds_read_b64_tr_b16 v[180:181], v43 offset:3584
    ds_read_b64_tr_b16 v[182:183], v42 offset:3072
    ds_read_b64_tr_b16 v[184:185], v42 offset:3584
    ds_read_b64_tr_b16 v[186:187], v42 offset:19456
    ds_read_b64_tr_b16 v[188:189], v42 offset:19968
    s_waitcnt lgkmcnt(15)
    v_mfma_f32_16x16x32_bf16 v[112:115], v[16:19], v[124:127], 0
    v_mfma_f32_16x16x32_bf16 v[116:119], v[16:19], v[128:131], 0
    v_mfma_f32_16x16x32_bf16 v[120:123], v[16:19], v[132:135], 0
    v_mfma_f32_16x16x32_bf16 v[100:103], v[124:127], v[124:127], 0
    v_mfma_f32_16x16x32_bf16 v[104:107], v[128:131], v[128:131], 0
    v_mfma_f32_16x16x32_bf16 v[108:111], v[132:135], v[132:135], 0
    v_mfma_f32_16x16x32_bf16 v[112:115], v[16:19], v[136:139], v[112:115]
    s_waitcnt lgkmcnt(14)
    v_mfma_f32_16x16x32_bf16 v[116:119], v[16:19], v[140:143], v[116:119]
    s_waitcnt lgkmcnt(12)
    v_mfma_f32_16x16x32_bf16 v[120:123], v[16:19], v[144:147], v[120:123]
    s_waitcnt lgkmcnt(10)
    v_mfma_f32_16x16x32_bf16 v[112:115], v[16:19], v[148:151], v[112:115]
    s_waitcnt lgkmcnt(8)
    v_mfma_f32_16x16x32_bf16 v[116:119], v[16:19], v[152:155], v[116:119]
    s_waitcnt lgkmcnt(6)
    v_mfma_f32_16x16x32_bf16 v[120:123], v[16:19], v[156:159], v[120:123]
    s_waitcnt lgkmcnt(4)
    v_mfma_f32_16x16x32_bf16 v[112:115], v[16:19], v[178:181], v[112:115]
    s_waitcnt lgkmcnt(2)
    v_mfma_f32_16x16x32_bf16 v[116:119], v[16:19], v[182:185], v[116:119]
    s_waitcnt lgkmcnt(0)
    v_mfma_f32_16x16x32_bf16 v[120:123], v[16:19], v[186:189], v[120:123]
    v_mfma_f32_16x16x32_bf16 v[100:103], v[136:139], v[136:139], v[100:103]
    v_mfma_f32_16x16x32_bf16 v[104:107], v[140:143], v[140:143], v[104:107]
    v_mfma_f32_16x16x32_bf16 v[108:111], v[144:147], v[144:147], v[108:111]
    v_mfma_f32_16x16x32_bf16 v[100:103], v[148:151], v[148:151], v[100:103]
    s_nop 1
    v_add_f32 v252, v112, v116
    s_nop 0
    v_cmp_u_f32 vcc, v252, v120
    s_cbranch_vccnz sr10
    s_branch so10
sr11:
    s_cmp_eq_u32 s27, 0
    s_cbranch_scc1 so11
    s_sub_u32 s27, s27, 1
    s_add_u32 s36, s64, 1048576
    s_add_u32 s38, s36, 16384
    s_sub_u32 s37, s36, 16384
    s_add_u32 m0, s66, 81920
    s_nop 0
    buffer_load_dwordx4 v4, s[4:7], s37 offen offset:0 sc1 lds
    s_add_u32 m0, s66, 32768
    s_nop 0
    buffer_load_dwordx4 v4, s[4:7], s36 offen offset:0 sc1 lds
    s_add_u32 m0, s66, 49152
    s_nop 0
    buffer_load_dwordx4 v4, s[4:7], s38 offen offset:0 sc1 lds
    s_add_u32 m0, s66, 81920
    s_nop 0
    buffer_load_dwordx4 v4, s[4:7], s37 offen offset:1024 sc1 lds
    s_add_u32 m0, s66, 32768
    s_nop 0
    buffer_load_dwordx4 v4, s[4:7], s36 offen offset:1024 sc1 lds
    s_add_u32 m0, s66, 49152
    s_nop 0
    buffer_load_dwordx4 v4, s[4:7], s38 offen offset:1024 sc1 lds
    s_add_u32 m0, s66, 81920
    s_nop 0
    buffer_load_dwordx4 v4, s[4:7], s37 offen offset:2048 sc1 lds
    s_add_u32 m0, s66, 32768
    s_nop 0
    buffer_load_dwordx4 v4, s[4:7], s36 offen offset:2048 sc1 lds
    s_add_u32 m0, s66, 49152
    s_nop 0
    buffer_load_dwordx4 v4, s[4:7], s38 offen offset:2048 sc1 lds
    s_add_u32 m0, s66, 81920
    s_nop 0
    buffer_load_dwordx4 v4, s[4:7], s37 offen offset:3072 sc1 lds
    s_add_u32 m0, s66, 32768
    s_nop 0
    buffer_load_dwordx4 v4, s[4:7], s36 offen offset:3072 sc1 lds
    s_add_u32 m0, s66, 49152
    s_nop 0
    buffer_load_dwordx4 v4, s[4:7], s38 offen offset:3072 sc1 lds
    s_waitcnt vmcnt(0) lgkmcnt(0)
    ds_read_b64_tr_b16 v[124:125], v43 offset:16384
    ds_read_b64_tr_b16 v[126:127], v43 offset:16896
    ds_read_b64_tr_b16 v[128:129], v42 offset:32768
    ds_read_b64_tr_b16 v[130:131], v42 offset:33280
    ds_read_b64_tr_b16 v[132:133], v42 offset:49152
    ds_read_b64_tr_b16 v[134:135], v42 offset:49664
    ds_read_b64_tr_b16 v[136:137], v43 offset:17408
    ds_read_b64_tr_b16 v[138:139], v43 offset:17920
    ds_read_b64_tr_b16 v[140:141], v42 offset:33792
    ds_read_b64_tr_b16 v[142:143], v42 offset:34304
    ds_read_b64_tr_b16 v[144:145], v42 offset:50176
    ds_read_b64_tr_b16 v[146:147], v42 offset:50688
    ds_read_b64_tr_b16 v[148:149], v43 offset:18432
    ds_read_b64_tr_b16 v[150:151], v43 offset:18944
    ds_read_b64_tr_b16 v[152:153], v42 offset:34816
    ds_read_b64_tr_b16 v[154:155], v42 offset:35328
    ds_read_b64_tr_b16 v[156:157], v42 offset:51200
    ds_read_b64_tr_b16 v[158:159], v42 offset:51712
    ds_read_b64_tr_b16 v[178:179], v43 offset:19456
    ds_read_b64_tr_b16 v[180:181], v43 offset:19968
    ds_read_b64_tr_b16 v[182:183], v42 offset:35840
    ds_read_b64_tr_b16 v[184:185], v42 offset:36352
    ds_read_b64_tr_b16 v[186:187], v42 offset:52224
    ds_read_b64_tr_b16 v[188:189], v42 offset:52736
    s_waitcnt lgkmcnt(15)
    v_mfma_f32_16x16x32_bf16 v[112:115], v[16:19], v[124:127], 0
    v_mfma_f32_16x16x32_bf16 v[116:119], v[16:19], v[128:131], 0
    v_mfma_f32_16x16x32_bf16 v[120:123], v[16:19], v[132:135], 0
    v_mfma_f32_16x16x32_bf16 v[100:103], v[124:127], v[124:127], 0
    v_mfma_f32_16x16x32_bf16 v[104:107], v[128:131], v[128:131], 0
    v_mfma_f32_16x16x32_bf16 v[108:111], v[132:135], v[132:135], 0
    v_mfma_f32_16x16x32_bf16 v[112:115], v[16:19], v[136:139], v[112:115]
    s_waitcnt lgkmcnt(14)
    v_mfma_f32_16x16x32_bf16 v[116:119], v[16:19], v[140:143], v[116:119]
    s_waitcnt lgkmcnt(12)
    v_mfma_f32_16x16x32_bf16 v[120:123], v[16:19], v[144:147], v[120:123]
    s_waitcnt lgkmcnt(10)
    v_mfma_f32_16x16x32_bf16 v[112:115], v[16:19], v[148:151], v[112:115]
    s_waitcnt lgkmcnt(8)
    v_mfma_f32_16x16x32_bf16 v[116:119], v[16:19], v[152:155], v[116:119]
    s_waitcnt lgkmcnt(6)
    v_mfma_f32_16x16x32_bf16 v[120:123], v[16:19], v[156:159], v[120:123]
    s_waitcnt lgkmcnt(4)
    v_mfma_f32_16x16x32_bf16 v[112:115], v[16:19], v[178:181], v[112:115]
    s_waitcnt lgkmcnt(2)
    v_mfma_f32_16x16x32_bf16 v[116:119], v[16:19], v[182:185], v[116:119]
    s_waitcnt lgkmcnt(0)
    v_mfma_f32_16x16x32_bf16 v[120:123], v[16:19], v[186:189], v[120:123]
    v_mfma_f32_16x16x32_bf16 v[100:103], v[136:139], v[136:139], v[100:103]
    v_mfma_f32_16x16x32_bf16 v[104:107], v[140:143], v[140:143], v[104:107]
    v_mfma_f32_16x16x32_bf16 v[108:111], v[144:147], v[144:147], v[108:111]
    v_mfma_f32_16x16x32_bf16 v[100:103], v[148:151], v[148:151], v[100:103]
    s_nop 1
    v_add_f32 v252, v112, v116
    s_nop 0
    v_cmp_u_f32 vcc, v252, v120
    s_cbranch_vccnz sr11
    s_branch so11
code_end:
.section .rodata,"a"
.p2align 6
.amdhsa_kernel interleave_layers__ssm_conv_s4__sliding_local_dilated__prompt_kernel
  .amdhsa_next_free_vgpr 512
  .amdhsa_next_free_sgpr 100
  .amdhsa_accum_offset 256
  .amdhsa_group_segment_fixed_size 0
  .amdhsa_kernarg_size 120
  .amdhsa_user_sgpr_count 2
  .amdhsa_user_sgpr_kernarg_segment_ptr 1
  .amdhsa_system_sgpr_workgroup_id_x 1
  .amdhsa_float_denorm_mode_32 3
.end_amdhsa_kernel
```
